```python
import torch

def _softmax(x, axis=-1):
    return torch.softmax(x, dim=axis)
def _gelu(x):
    return torch.nn.functional.gelu(x, approximate="tanh")
def _silu(x):
    return torch.nn.functional.silu(x)
def _sigmoid(x):
    return torch.sigmoid(x)
def _layernorm(x, axis=-1, eps=1e-5):
    m = x.mean(dim=axis, keepdim=True)
    v = x.var(dim=axis, keepdim=True, unbiased=False)
    return (x - m) / torch.sqrt(v + eps)
def _scatter_add(tgt, idx, src, axis=0):
    return tgt.clone().index_add_(axis, idx, src)
def _segment_sum(src, seg, n):
    out = torch.zeros((n,) + src.shape[1:], dtype=src.dtype)
    return out.index_add_(0, seg, src)
def _pad(x, pw):
    flat = tuple(v for pair in reversed(pw) for v in pair)
    return torch.nn.functional.pad(x, flat)

kernel_name = 'sequential_preLN__spectral_fnet__swiglu_ffn__prompt'

def setup_inputs():

    _w = (lambda a: (lambda t: t.to(torch.bfloat16) if t.is_floating_point() else t)(torch.as_tensor(a)))
    def _A_setup():
        B, S, D = 1, 2048, 512
        ns = torch.arange(S)[:, None] * torch.arange(S)[None, :]
        nd = torch.arange(D)[:, None] * torch.arange(D)[None, :]
        Ws_re = torch.cos(-2.0 * torch.pi * ns / S).to(float)
        Ws_im = torch.sin(-2.0 * torch.pi * ns / S).to(float)
        Wd_re = torch.cos(-2.0 * torch.pi * nd / D).to(float)
        Wd_im = torch.sin(-2.0 * torch.pi * nd / D).to(float)
        return {
            "x": _w((lambda *s: torch.randn(*s, dtype=torch.bfloat16) * 0.05)(B, S, D)),
            "dft_seq_re": _w(Ws_re),
            "dft_seq_im": _w(Ws_im),
            "dft_hid_re": _w(Wd_re),
            "dft_hid_im": _w(Wd_im),
        }
    _A_in = _A_setup()

    def _B_setup():
        B, S, D, F = 1, 2048, 512, 1792
        return {
            "x": _w((lambda *s: torch.randn(*s, dtype=torch.bfloat16) * 0.05)(B, S, D)),
            "w_gate": _w((lambda *s: torch.randn(*s, dtype=torch.bfloat16) * 0.2)(D, F)),
            "w_up": _w((lambda *s: torch.randn(*s, dtype=torch.bfloat16) * 0.2)(D, F)),
            "w_down": _w((lambda *s: torch.randn(*s, dtype=torch.bfloat16) * 0.2)(F, D)),
        }
    _B_in = _B_setup()

    return {
        "A_x": _A_in["x"],
        "A_dft_seq_re": _A_in["dft_seq_re"],
        "A_dft_seq_im": _A_in["dft_seq_im"],
        "A_dft_hid_re": _A_in["dft_hid_re"],
        "A_dft_hid_im": _A_in["dft_hid_im"],
        "B_x": _B_in["x"],
        "B_w_gate": _B_in["w_gate"],
        "B_w_up": _B_in["w_up"],
        "B_w_down": _B_in["w_down"],
    }

def reference(A_x, A_dft_seq_re, A_dft_seq_im, A_dft_hid_re, A_dft_hid_im, B_x, B_w_gate, B_w_up, B_w_down):
    def _A_ref(x, dft_seq_re, dft_seq_im, dft_hid_re, dft_hid_im):
        a = torch.einsum("bsd,ed->bse", x, dft_hid_re)
        b = torch.einsum("bsd,ed->bse", x, dft_hid_im)
        y = torch.einsum("ts,bse->bte", dft_seq_re, a) - torch.einsum("ts,bse->bte", dft_seq_im, b)
        return y

    def _B_ref(x, w_gate, w_up, w_down):
        g = _silu(x @ w_gate)
        u = x @ w_up
        return (g * u) @ w_down

    x = A_x
    h = x + _A_ref(_layernorm(x, axis=-1), A_dft_seq_re, A_dft_seq_im, A_dft_hid_re, A_dft_hid_im)
    h2 = h + _B_ref(_layernorm(h, axis=-1), B_w_gate, B_w_up, B_w_down)
    return h2
```

```asm
; @launch grid=(256,1,1) block=(256,1,1) lds=163840
.amdgcn_target "amdgcn-amd-amdhsa--gfx950"
.text
.p2align 12
.fill 832, 4, 0xbf810000
.globl sequential_preLN__spectral_fnet__swiglu_ffn__prompt_kernel
.p2align 8
.type sequential_preLN__spectral_fnet__swiglu_ffn__prompt_kernel,@function
sequential_preLN__spectral_fnet__swiglu_ffn__prompt_kernel:
    s_load_dwordx2 s[4:5], s[0:1], 0
    s_load_dwordx2 s[8:9], s[0:1], 88
    s_load_dwordx2 s[12:13], s[0:1], 48
    s_load_dwordx2 s[16:17], s[0:1], 56
    s_load_dwordx2 s[20:21], s[0:1], 64
    s_load_dwordx2 s[24:25], s[0:1], 72
    s_cmp_ge_u32 s2, 256
    s_cbranch_scc1 L_end
    v_lshrrev_b32 v2, 6, v0
    v_and_b32 v1, 63, v0
    s_getpc_b64 s[28:29]
L_pc:
    s_lshr_b32 s34, s2, 3
    s_lshl_b32 s41, s34, 10
    v_lshl_add_u32 v8, v2, 1, v1
    v_lshl_add_u32 v8, v8, 7, s41
    v_min_u32 v8, L_last-L_pc, v8
    v_mov_b32 v9, s29
    v_add_co_u32 v8, vcc, s28, v8
    s_nop 1
    v_addc_co_u32 v9, vcc, 0, v9, vcc
    s_mov_b64 exec, 3
    global_load_dword v0, v[8:9], off
    s_mov_b64 exec, -1
    v_readfirstlane_b32 s32, v2
    s_mov_b32 s6, 2097152
    s_mov_b32 s7, 0x20000
    s_mov_b32 s10, 20971520
    s_mov_b32 s11, s7
    s_mov_b32 s14, 1835008
    s_mov_b32 s15, s7
    s_mov_b64 s[18:19], s[14:15]
    s_mov_b64 s[22:23], s[14:15]
    s_mov_b64 s[30:31], s[14:15]
    s_mov_b64 s[26:27], s[6:7]
    s_and_b32 s33, s2, 7
    s_lshr_b32 s34, s2, 3
    s_lshr_b32 s55, s34, 4
    s_lshl1_add_u32 s55, s33, s55
    s_sub_u32 s60, 32, s55
    s_cmp_eq_u32 s55, 0
    s_cselect_b32 s64, 16, s60
    s_bitcmp1_b32 s34, 3
    s_cselect_b32 s60, s64, s55
    s_and_b32 s39, s34, 4
    s_lshl3_add_u32 s60, s39, s60
    s_lshl_b32 s39, s32, 19
    s_lshl_b32 s40, s60, 10
    s_add_u32 s92, s39, s40
    s_add_u32 s93, s92, 0x40000
    v_lshlrev_b32 v2, 4, v1
    v_and_b32 v3, 15, v1
    v_lshrrev_b32 v4, 4, v1
    v_and_b32 v5, 3, v1
    v_lshl_add_u32 v5, v4, 2, v5
    v_lshlrev_b32 v5, 4, v5
    v_lshrrev_b32 v6, 2, v3
    v_lshl_add_u32 v7, v6, 16, v5
    s_and_b32 s61, s34, 1
    s_bfe_u32 s62, s34, 0x10001
    v_mul_u32_u24 v16, 1040, v6
    s_mul_i32 s39, s32, 8320
    s_add_u32 s39, s39, 113664
    v_add3_u32 v16, v16, v5, s39
    v_and_b32 v9, 1, v1
    v_cmp_eq_u32 vcc, 1, v9
    v_mov_b32 v10, 0x3f803f80
    s_nop 0
    v_cndmask_b32 v236, 0, v10, vcc
    v_xor_b32 v232, v10, v236
    v_mov_b32 v237, v236
    v_mov_b32 v233, v232
    v_mov_b32 v238, v236
    v_mov_b32 v234, v232
    v_mov_b32 v239, v236
    v_mov_b32 v235, v232
    s_lshl_b32 s39, s62, 3
    v_add_u32 v10, s39, v3
    v_cvt_f32_u32 v11, v10
    v_mul_f32 v11, 0xbd000000, v11
    v_lshlrev_b32 v12, 3, v4
    v_cvt_f32_u32 v12, v12
    v_mul_f32 v12, v11, v12
    v_cos_f32 v152, v12
    v_sin_f32 v160, v12
    v_add_f32 v12, v12, v11
    v_cos_f32 v153, v12
    v_sin_f32 v161, v12
    v_add_f32 v12, v12, v11
    v_cos_f32 v154, v12
    v_sin_f32 v162, v12
    v_add_f32 v12, v12, v11
    v_cos_f32 v155, v12
    v_sin_f32 v163, v12
    v_add_f32 v12, v12, v11
    v_cos_f32 v156, v12
    v_sin_f32 v164, v12
    v_add_f32 v12, v12, v11
    v_cos_f32 v157, v12
    v_sin_f32 v165, v12
    v_add_f32 v12, v12, v11
    v_cos_f32 v158, v12
    v_sin_f32 v166, v12
    v_add_f32 v12, v12, v11
    v_cos_f32 v159, v12
    v_sin_f32 v167, v12
    v_bfe_u32 v11, v1, 3, 1
    v_lshlrev_b32 v11, 17, v11
    v_and_b32 v12, 0x70, v2
    v_lshl_add_u32 v18, v4, 7, v12
    s_lshl_b32 s39, s62, 8
    v_add3_u32 v18, v18, v11, s39
    v_xor_b32 v19, 512, v18
    v_cvt_pk_bf16_f32 v128, v152, v153
    v_cvt_pk_bf16_f32 v136, v160, v161
    v_cvt_pk_bf16_f32 v129, v154, v155
    v_cvt_pk_bf16_f32 v137, v162, v163
    v_cvt_pk_bf16_f32 v130, v156, v157
    v_cvt_pk_bf16_f32 v138, v164, v165
    v_cvt_pk_bf16_f32 v131, v158, v159
    v_cvt_pk_bf16_f32 v139, v166, v167
    s_mov_b32 s41, 0x80000000
    s_mov_b32 s42, 0x80008000
    s_mov_b32 s43, 0x8000
    v_xor_b32 v132, s41, v128
    v_xor_b32 v140, s41, v136
    v_xor_b32 v144, s42, v136
    v_xor_b32 v148, s43, v136
    v_xor_b32 v133, s41, v129
    v_xor_b32 v141, s41, v137
    v_xor_b32 v145, s42, v137
    v_xor_b32 v149, s43, v137
    v_xor_b32 v134, s41, v130
    v_xor_b32 v142, s41, v138
    v_xor_b32 v146, s42, v138
    v_xor_b32 v150, s43, v138
    v_xor_b32 v135, s41, v131
    v_xor_b32 v143, s41, v139
    v_xor_b32 v147, s42, v139
    v_xor_b32 v151, s43, v139
    s_waitcnt lgkmcnt(0)
    buffer_load_dwordx4 v[64:67], v7, s[4:7], s92 offen offset:0
    buffer_load_dwordx4 v[68:71], v7, s[4:7], s92 offen offset:256
    buffer_load_dwordx4 v[72:75], v7, s[4:7], s92 offen offset:512
    buffer_load_dwordx4 v[76:79], v7, s[4:7], s92 offen offset:768
    buffer_load_dwordx4 v[80:83], v7, s[4:7], s93 offen offset:0
    buffer_load_dwordx4 v[84:87], v7, s[4:7], s93 offen offset:256
    buffer_load_dwordx4 v[88:91], v7, s[4:7], s93 offen offset:512
    buffer_load_dwordx4 v[92:95], v7, s[4:7], s93 offen offset:768
    s_add_u32 s94, s8, 2617344
    s_addc_u32 s95, s9, 0
    s_load_dword s37, s[94:95], 0
    s_and_b32 s35, s33, 1
    s_lshl_b32 s35, s35, 3
    s_and_b32 s39, s34, 7
    s_or_b32 s35, s35, s39
    s_lshr_b32 s36, s33, 1
    s_lshl_b32 s36, s36, 2
    s_lshr_b32 s39, s34, 3
    s_or_b32 s36, s36, s39
    s_lshl_b32 s38, s35, 2
    s_add_u32 s38, s38, s32
    s_mul_i32 s63, s32, 229376
    s_lshl2_add_u32 s52, s62, s32
    s_lshl1_add_u32 s40, s60, s61
    s_lshl_b32 s39, s52, 8
    s_add_u32 s39, s39, s40
    s_lshl_b32 s53, s39, 10
    s_lshl2_add_u32 s41, s2, s32
    s_lshl_b32 s48, s41, 11
    s_add_u32 s48, s48, 2621440
    s_lshl_b32 s49, s41, 7
    s_add_u32 s49, s49, 2375680
    s_lshl4_add_u32 s41, s61, s52
    s_lshl_b32 s54, s60, 10
    s_add_u32 s54, s54, 2228224
    s_cmp_eq_u32 s41, 2
    s_cselect_b32 s54, s54, 0x40000000
    v_mov_b32 v252, -1
    v_mov_b32 v253, -1
    v_mov_b32 v254, -1
    v_mov_b32 v255, -1
    s_cmp_eq_u32 s61, 1
    s_cselect_b32 s28, s16, s12
    s_cselect_b32 s29, s17, s13
    s_lshr_b32 s40, s34, 1
    s_lshl2_add_u32 s101, s40, s32
    s_mul_i32 s101, s101, 28672
    s_lshr_b32 s66, s33, 1
    s_mul_i32 s66, s66, 512
    s_add_u32 s66, s66, s101
    v_lshrrev_b32 v30, 2, v1
    v_mul_u32_u24 v30, 3584, v30
    v_and_b32 v31, 3, v1
    v_lshl_add_u32 v30, v31, 7, v30
    s_mov_b32 exec_hi, 0
    buffer_load_dword v0, v30, s[28:31], s66 offen offset:0
    s_mov_b64 exec, -1
    s_lshr_b32 s39, s34, 3
    s_mul_i32 s39, s39, 3
    s_add_u32 s39, s39, s32
    s_sub_u32 s39, s39, 1
    s_bfe_u32 s40, s34, 0x20001
    s_lshl2_add_u32 s40, s33, s40
    s_mul_i32 s56, s40, 57344
    s_lshl_b32 s41, s39, 7
    s_add_u32 s56, s56, s41
    s_add_u32 s56, s56, 2048
    s_add_u32 s57, s41, s40
    s_lshl2_add_u32 s57, s57, s61
    s_lshl_b32 s57, s57, 8
    s_add_u32 s57, s57, 18874368
    s_cmp_eq_u32 s32, 0
    s_cselect_b32 s56, 0x40000000, s56
    s_cselect_b32 s57, 0x40000000, s57
    v_lshrrev_b32 v26, 3, v1
    v_and_b32 v27, 7, v1
    v_mul_u32_u24 v28, 3584, v26
    v_and_b32 v26, 2, v26
    v_xor_b32 v27, v27, v26
    v_lshl_add_u32 v20, v27, 4, v28
    v_xor_b32 v21, 64, v20
    s_lshl_b32 s39, s61, 3
    v_lshrrev_b32 v10, 1, v3
    v_add_u32 v10, s39, v10
    v_cvt_f32_u32 v11, v10
    v_mul_f32 v11, 0x3b000000, v11
    s_lshl_b32 s39, s32, 3
    v_lshl_add_u32 v12, v4, 5, s39
    v_cvt_f32_u32 v13, v12
    v_cmp_ne_u32 s[46:47], 0, v12
    v_cvt_f32_u32 v12, v9
    v_mul_f32 v12, 0x3e800000, v12
    v_fmac_f32 v12, v11, v13
    v_and_b32 v13, 1, v10
    v_lshlrev_b32 v14, 4, v13
    v_mul_lo_u32 v15, v13, s42
    v_bfe_u32 v10, v10, 1, 1
    v_mul_lo_u32 v10, v10, s42
    v_lshlrev_b32 v13, 15, v13
    v_xor_b32 v13, v13, v10
    v_cos_f32 v26, v12
    v_sin_f32 v27, v12
    v_add_f32 v12, v12, v11
    v_cvt_pk_bf16_f32 v96, v26, v27
    v_alignbit_b32 v97, v96, v96, v14
    v_xor_b32 v98, v15, v96
    v_xor_b32 v97, v13, v97
    v_xor_b32 v99, v15, v97
    v_cos_f32 v26, v12
    v_sin_f32 v27, v12
    v_add_f32 v12, v12, v11
    v_cvt_pk_bf16_f32 v100, v26, v27
    v_alignbit_b32 v101, v100, v100, v14
    v_xor_b32 v102, v15, v100
    v_xor_b32 v101, v13, v101
    v_xor_b32 v103, v15, v101
    v_cos_f32 v26, v12
    v_sin_f32 v27, v12
    v_add_f32 v12, v12, v11
    v_cvt_pk_bf16_f32 v104, v26, v27
    v_alignbit_b32 v105, v104, v104, v14
    v_xor_b32 v106, v15, v104
    v_xor_b32 v105, v13, v105
    v_xor_b32 v107, v15, v105
    s_lshl_b32 s66, s32, 11
    s_add_u32 m0, s66, 98304
    s_add_u32 s66, s56, 27648
    buffer_load_dwordx4 v20, s[28:31], s56 offen lds
    buffer_load_dwordx4 v20, s[28:31], s66 offen offset:1024 lds
    v_cos_f32 v26, v12
    v_sin_f32 v27, v12
    v_add_f32 v12, v12, v11
    v_cvt_pk_bf16_f32 v108, v26, v27
    v_alignbit_b32 v109, v108, v108, v14
    v_xor_b32 v110, v15, v108
    v_xor_b32 v109, v13, v109
    v_xor_b32 v111, v15, v109
    v_cos_f32 v26, v12
    v_sin_f32 v27, v12
    v_add_f32 v12, v12, v11
    v_cvt_pk_bf16_f32 v112, v26, v27
    v_alignbit_b32 v113, v112, v112, v14
    v_xor_b32 v114, v15, v112
    v_xor_b32 v113, v13, v113
    v_xor_b32 v115, v15, v113
    v_cos_f32 v26, v12
    v_sin_f32 v27, v12
    v_add_f32 v12, v12, v11
    v_cvt_pk_bf16_f32 v116, v26, v27
    v_alignbit_b32 v117, v116, v116, v14
    v_xor_b32 v118, v15, v116
    v_xor_b32 v117, v13, v117
    v_xor_b32 v119, v15, v117
    v_cos_f32 v26, v12
    v_sin_f32 v27, v12
    v_add_f32 v12, v12, v11
    v_cvt_pk_bf16_f32 v120, v26, v27
    v_alignbit_b32 v121, v120, v120, v14
    v_xor_b32 v122, v15, v120
    v_xor_b32 v121, v13, v121
    v_xor_b32 v123, v15, v121
    v_cos_f32 v26, v12
    v_sin_f32 v27, v12
    s_nop 0
    v_cvt_pk_bf16_f32 v124, v26, v27
    v_alignbit_b32 v125, v124, v124, v14
    v_xor_b32 v126, v15, v124
    v_xor_b32 v125, v13, v125
    v_xor_b32 v127, v15, v125
    v_cndmask_b32 v96, 0, v96, s[46:47]
    v_lshl_add_u32 v11, v4, 3, v6
    v_mul_u32_u24 v11, 1040, v11
    v_and_b32 v12, 3, v1
    v_lshl_add_u32 v11, v12, 6, v11
    s_lshl_b32 s39, s32, 4
    s_add_u32 s39, s39, 113664
    v_add_u32 v17, s39, v11
    v_lshl_add_u32 v12, v9, 2, v4
    s_lshl_b32 s39, s32, 3
    v_add_u32 v12, s39, v12
    s_mov_b32 s39, 146944
    v_lshl_add_u32 v13, v12, 1, s39
    v_lshl_add_u32 v12, v12, 2, s39
    v_lshl_add_u32 v14, v4, 4, s39
    v_lshl_add_u32 v15, v4, 5, s39
    s_mov_b64 exec, 0
    s_cmp_eq_u32 s32, 0
    s_cbranch_scc1 L_pg1
L_ret_t:
    s_mov_b64 exec, -1
    s_waitcnt vmcnt(10)
    v_mfma_f32_16x16x32_bf16 v[240:243], v[64:67], v[64:67], 0
    ds_write_b128 v16, v[64:67] offset:0
    v_mfma_f32_16x16x32_bf16 v[248:251], v[64:67], v[232:235], 0
    s_and_b32 s39, s34, 3
    s_lshl_b32 s40, s60, 7
    s_lshl2_add_u32 s39, s39, s40
    s_add_u32 s39, s39, 2293760
    s_cmp_eq_u32 s32, 3
    s_cselect_b32 s44, s39, 0x40000000
    s_waitcnt vmcnt(9)
    v_mfma_f32_16x16x32_bf16 v[240:243], v[68:71], v[68:71], v[240:243]
    ds_write_b128 v16, v[68:71] offset:256
    v_mfma_f32_16x16x32_bf16 v[248:251], v[68:71], v[232:235], v[248:251]
    v_lshlrev_b32 v22, 2, v1
    v_add_u32 v23, 147200, v22
    v_and_b32 v24, 31, v1
    v_mul_u32_u24 v24, 1040, v24
    v_add_u32 v24, 113664, v24
    v_bfe_u32 v26, v1, 2, 2
    s_waitcnt vmcnt(8)
    v_mfma_f32_16x16x32_bf16 v[240:243], v[72:75], v[72:75], v[240:243]
    ds_write_b128 v16, v[72:75] offset:512
    v_mfma_f32_16x16x32_bf16 v[248:251], v[72:75], v[232:235], v[248:251]
    buffer_store_dwordx4 v[252:255], v2, s[8:11], s48 offen sc1
    v_and_b32 v27, 32, v1
    v_lshlrev_b32 v27, 5, v27
    v_lshl_add_u32 v27, v26, 7, v27
    v_lshlrev_b32 v26, 3, v26
    v_xor_b32 v26, v26, v1
    s_waitcnt vmcnt(8)
    v_mfma_f32_16x16x32_bf16 v[240:243], v[76:79], v[76:79], v[240:243]
    ds_write_b128 v16, v[76:79] offset:768
    v_mfma_f32_16x16x32_bf16 v[248:251], v[76:79], v[232:235], v[248:251]
    v_and_b32 v26, 16, v26
    v_lshl_add_u32 v27, v26, 1, v27
    v_and_b32 v26, 1, v1
    v_lshl_add_u32 v27, v26, 4, v27
    v_and_b32 v26, 2, v1
    s_waitcnt vmcnt(7)
    v_mfma_f32_16x16x32_bf16 v[244:247], v[80:83], v[80:83], 0
    ds_write_b128 v16, v[80:83] offset:4160
    v_mfma_f32_16x16x32_bf16 v[248:251], v[80:83], v[236:239], v[248:251]
    buffer_store_dwordx4 v[252:255], v2, s[8:11], s48 offen offset:1024 sc1
    v_lshl_add_u32 v27, v26, 2, v27
    s_lshl_b32 s66, s32, 11
    s_add_u32 s66, s66, 98304
    v_add_u32 v7, s66, v27
    v_and_b32 v26, 16, v1
    s_waitcnt vmcnt(7)
    v_mfma_f32_16x16x32_bf16 v[244:247], v[84:87], v[84:87], v[244:247]
    ds_write_b128 v16, v[84:87] offset:4416
    v_mfma_f32_16x16x32_bf16 v[248:251], v[84:87], v[236:239], v[248:251]
    v_and_b32 v25, 0x2f0, v2
    v_lshl_add_u32 v25, v26, 11, v25
    s_lshl_b32 s39, s32, 8
    s_add_u32 s39, s39, 147456
    v_lshlrev_b32 v10, 12, v4
    s_waitcnt vmcnt(6)
    v_mfma_f32_16x16x32_bf16 v[244:247], v[88:91], v[88:91], v[244:247]
    ds_write_b128 v16, v[88:91] offset:4672
    v_mfma_f32_16x16x32_bf16 v[248:251], v[88:91], v[236:239], v[248:251]
    s_mov_b64 exec, 0xff
    buffer_store_dwordx4 v[252:255], v2, s[8:11], s49 offen sc1
    s_mov_b64 exec, -1
    v_lshl_add_u32 v10, v3, 4, v10
    v_add_u32 v10, s39, v10
    v_lshrrev_b32 v11, 3, v3
    v_lshlrev_b32 v11, 10, v11
    v_lshl_add_u32 v11, v4, 8, v11
    s_waitcnt vmcnt(6)
    v_mfma_f32_16x16x32_bf16 v[244:247], v[92:95], v[92:95], v[244:247]
    ds_write_b128 v16, v[92:95] offset:4928
    v_mfma_f32_16x16x32_bf16 v[248:251], v[92:95], v[236:239], v[248:251]
    v_and_b32 v26, 7, v1
    v_lshl_add_u32 v11, v26, 5, v11
    s_lshl_b32 s39, s32, 11
    s_add_u32 s39, s39, 147456
    v_add_u32 v11, s39, v11
    s_lshl2_add_u32 s59, s34, s32
    s_cmp_lt_u32 s59, 64
    s_cselect_b32 s66, 0, 192
    s_cselect_b32 s65, 64, 48
    s_lshr_b32 s3, s33, 1
    s_mul_i32 s3, s3, s65
    s_add_u32 s3, s3, s66
    s_add_u32 s3, s3, s59
    s_cmp_lt_u32 s59, 112
    s_cselect_b32 s3, s3, 0x1000
    s_lshl_b32 s3, s3, 12
    v_lshlrev_b32 v31, 7, v1
    s_lshr_b32 s59, s59, 2
    s_bitcmp1_b32 0x9240000, s59
    s_cselect_b32 s65, 393088, 0
    s_lshr_b32 s66, s33, 2
    s_mul_i32 s66, s66, s65
    s_sub_u32 s3, s3, s66
    v_and_b32 v30, 1, v1
    v_mad_u32_u24 v31, v30, s65, v31
    s_mov_b32 exec_hi, 0
    buffer_load_dword v0, v31, s[20:23], s3 offen
    s_mov_b64 exec, -1
    v_mov_b32_dpp v26, v240 quad_perm:[0,0,0,0] row_mask:0xf bank_mask:0xf
    v_mov_b32_dpp v27, v244 quad_perm:[0,0,0,0] row_mask:0xf bank_mask:0xf
    s_nop 0
    v_add_f32_dpp v26, v241, v26 quad_perm:[1,1,1,1] row_mask:0xf bank_mask:0xf
    v_add_f32_dpp v27, v245, v27 quad_perm:[1,1,1,1] row_mask:0xf bank_mask:0xf
    v_add_f32 v248, v248, v249
    v_add_f32_dpp v26, v242, v26 quad_perm:[2,2,2,2] row_mask:0xf bank_mask:0xf
    v_add_f32_dpp v27, v246, v27 quad_perm:[2,2,2,2] row_mask:0xf bank_mask:0xf
    v_add_f32 v248, v248, v250
    v_add_f32_dpp v26, v243, v26 quad_perm:[3,3,3,3] row_mask:0xf bank_mask:0xf
    v_add_f32_dpp v27, v247, v27 quad_perm:[3,3,3,3] row_mask:0xf bank_mask:0xf
    v_add_f32 v248, v248, v251
    v_cndmask_b32 v27, v26, v27, vcc
    v_mul_f32 v26, 0x3b000000, v248
    v_mul_f32 v27, 0x3b000000, v27
    v_fma_f32 v27, -v26, v26, v27
    v_max_f32 v27, 0, v27
    v_add_f32 v27, 0x3727c5ac, v27
    v_rsq_f32 v27, v27
    v_cvt_pk_bf16_f32 v28, -v26, -v26
    v_lshlrev_b32 v29, 16, v28
    v_add_f32 v29, v29, v26
    v_cvt_pk_bf16_f32 v29, -v29, -v29
    s_mov_b32 exec_lo, 0x00300003
    s_mov_b32 exec_hi, 0x30000300
    ds_write_b32 v12, v27
    ds_write_b16 v13, v28 offset:128
    ds_write_b16 v13, v29 offset:192
    ds_write_b32 v12, v26 offset:256
    s_mov_b64 exec, -1
    s_waitcnt lgkmcnt(0)
    s_barrier
    ds_read_b128 v[32:35], v15
    ds_read_b128 v[36:39], v15 offset:16
    ds_read_b128 v[40:43], v14 offset:128
    ds_read_b128 v[44:47], v14 offset:192
    ds_read_b64_tr_b16 v[64:65], v17 offset:0
    ds_read_b64_tr_b16 v[66:67], v17 offset:4160
    ds_read_b64_tr_b16 v[68:69], v17 offset:256
    ds_read_b64_tr_b16 v[70:71], v17 offset:4416
    ds_read_b64_tr_b16 v[72:73], v17 offset:512
    ds_read_b64_tr_b16 v[74:75], v17 offset:4672
    ds_read_b64_tr_b16 v[76:77], v17 offset:768
    ds_read_b64_tr_b16 v[78:79], v17 offset:4928
    ds_read_b64_tr_b16 v[80:81], v17 offset:8
    ds_read_b64_tr_b16 v[82:83], v17 offset:4168
    s_lshl_b32 s66, s60, 7
    s_add_u32 s66, s66, 2293760
    v_mov_b32 v31, s66
    s_and_b32 s66, s34, 3
    s_lshl2_add_u32 s66, s60, s66
    s_lshl_b32 s66, s66, 7
    s_add_u32 s66, s66, 2326528
    v_writelane_b32 v31, s66, 1
    s_lshr_b32 s66, s36, 2
    s_lshl2_add_u32 s66, s38, s66
    s_lshl_b32 s66, s66, 7
    s_add_u32 s66, s66, 20447232
    v_writelane_b32 v31, s66, 2
    s_mov_b64 exec, 7
    buffer_load_dword v0, v31, s[8:11], 0 offen
    s_mov_b64 exec, -1
    s_add_u32 s37, s37, 0x9e3779b9
    s_cmp_lt_u32 s32, 2
    s_cselect_b32 s64, s55, s64
    s_and_b32 s92, s32, 1
    s_lshl_b32 s65, s92, 10
    s_add_u32 s65, s65, s64
    v_and_b32 v3, 31, v1
    v_lshrrev_b32 v4, 5, v1
    v_lshl_add_u32 v5, v3, 5, s65
    s_lshl_b32 s65, s65, 10
    s_cmp_gt_u32 s64, 16
    s_cselect_b32 s93, 0x80000000, 0
    s_cselect_b32 s99, s55, s64
    s_cselect_b32 s94, -1, 0
    s_or_b32 s93, s93, 0x3a000000
    s_bfe_u32 s3, s34, 0x30001
    s_lshl3_add_u32 s3, s3, s61
    s_lshl4_add_u32 s95, s3, s65
    s_add_u32 s96, s95, 523264
    s_lshl_b32 s97, s3, 3
    s_mov_b32 s98, 2293760
    s_lshl2_add_u32 s99, s99, s92
    s_lshl_b32 s99, s99, 15
    v_lshrrev_b32 v12, 2, v1
    v_bfe_u32 v13, v1, 4, 2
    s_waitcnt lgkmcnt(12)
    v_mul_f32 v152, v152, v32
    v_mul_f32 v153, v153, v33
    v_mul_f32 v154, v154, v34
    v_mul_f32 v155, v155, v35
    v_mul_f32 v156, v156, v36
    v_mul_f32 v157, v157, v37
    v_mul_f32 v158, v158, v38
    v_mul_f32 v159, v159, v39
    v_cvt_pk_bf16_f32 v48, v152, v153
    v_cvt_pk_bf16_f32 v49, v154, v155
    v_cvt_pk_bf16_f32 v50, v156, v157
    v_cvt_pk_bf16_f32 v51, v158, v159
    s_waitcnt lgkmcnt(8)
    ds_read_b64_tr_b16 v[84:85], v17 offset:264
    ds_read_b64_tr_b16 v[86:87], v17 offset:4424
    ds_read_b64_tr_b16 v[88:89], v17 offset:520
    ds_read_b64_tr_b16 v[90:91], v17 offset:4680
    ds_read_b64_tr_b16 v[92:93], v17 offset:776
    ds_read_b64_tr_b16 v[94:95], v17 offset:4936
    v_mfma_f32_16x16x32_bf16 v[56:59], v[40:43], v[48:51], 0
    v_mul_f32 v160, v160, v32
    v_mul_f32 v161, v161, v33
    v_mul_f32 v162, v162, v34
    v_mul_f32 v163, v163, v35
    v_mfma_f32_16x16x32_bf16 v[56:59], v[44:47], v[48:51], v[56:59]
    v_mul_f32 v164, v164, v36
    v_mul_f32 v165, v165, v37
    v_mul_f32 v166, v166, v38
    v_mul_f32 v167, v167, v39
    s_waitcnt lgkmcnt(14)
    v_mfma_f32_16x16x32_bf16 v[168:171], v[64:67], v[48:51], v[56:59]
    v_cvt_pk_bf16_f32 v52, v160, v161
    s_waitcnt lgkmcnt(12)
    v_mfma_f32_16x16x32_bf16 v[172:175], v[68:71], v[48:51], v[56:59]
    v_cvt_pk_bf16_f32 v53, v162, v163
    s_waitcnt lgkmcnt(10)
    v_mfma_f32_16x16x32_bf16 v[176:179], v[72:75], v[48:51], v[56:59]
    v_cvt_pk_bf16_f32 v54, v164, v165
    s_waitcnt lgkmcnt(8)
    v_mfma_f32_16x16x32_bf16 v[180:183], v[76:79], v[48:51], v[56:59]
    v_cvt_pk_bf16_f32 v55, v166, v167
    v_xor_b32 v13, v13, v1
    v_and_b32 v13, 3, v13
    v_mfma_f32_16x16x32_bf16 v[60:63], v[40:43], v[52:55], 0
    v_lshlrev_b32 v13, 5, v13
    v_lshl_add_u32 v6, v12, 15, v13
    v_mfma_f32_16x16x32_bf16 v[60:63], v[44:47], v[52:55], v[60:63]
    v_and_b32 v12, 15, v1
    v_and_b32 v13, 16, v1
    v_mfma_f32_16x16x32_bf16 v[200:203], v[64:67], v[52:55], v[60:63]
    v_lshl_add_u32 v12, v13, 1, v12
    v_lshl_add_u32 v12, s92, 4, v12
    v_mfma_f32_16x16x32_bf16 v[204:207], v[68:71], v[52:55], v[60:63]
    v_and_b32 v16, 63, v5
    v_sub_u32 v13, v16, v12
    v_mfma_f32_16x16x32_bf16 v[208:211], v[72:75], v[52:55], v[60:63]
    v_mad_i32_i24 v8, v13, v4, v12
    v_lshlrev_b32 v8, 7, v8
    v_mfma_f32_16x16x32_bf16 v[212:215], v[76:79], v[52:55], v[60:63]
    v_lshlrev_b32 v16, 10, v16
    v_lshrrev_b32 v12, 6, v5
    s_waitcnt lgkmcnt(0)
    v_mfma_f32_16x16x32_bf16 v[184:187], v[80:83], v[48:51], v[56:59]
    v_lshl_add_u32 v16, v12, 2, v16
    v_and_b32 v12, 3, v3
    v_mfma_f32_16x16x32_bf16 v[188:191], v[84:87], v[48:51], v[56:59]
    v_and_b32 v13, 4, v3
    v_lshl_or_b32 v12, v13, 2, v12
    v_mfma_f32_16x16x32_bf16 v[192:195], v[88:91], v[48:51], v[56:59]
    v_and_b32 v13, 16, v3
    v_lshl_or_b32 v12, v13, 1, v12
    v_mfma_f32_16x16x32_bf16 v[196:199], v[92:95], v[48:51], v[56:59]
    v_bfe_u32 v13, v3, 3, 1
    v_lshl_or_b32 v12, v13, 2, v12
    v_mfma_f32_16x16x32_bf16 v[216:219], v[80:83], v[52:55], v[60:63]
    v_cvt_pk_bf16_f32 v64, v168, v200
    v_cvt_pk_bf16_f32 v65, v172, v204
    v_cvt_pk_bf16_f32 v66, v176, v208
    v_cvt_pk_bf16_f32 v67, v180, v212
    v_mfma_f32_16x16x32_bf16 v[220:223], v[84:87], v[52:55], v[60:63]
    v_cvt_pk_bf16_f32 v68, v169, v201
    v_cvt_pk_bf16_f32 v69, v173, v205
    v_cvt_pk_bf16_f32 v70, v177, v209
    v_cvt_pk_bf16_f32 v71, v181, v213
    v_mfma_f32_16x16x32_bf16 v[224:227], v[88:91], v[52:55], v[60:63]
    v_cvt_pk_bf16_f32 v72, v170, v202
    v_cvt_pk_bf16_f32 v73, v174, v206
    v_cvt_pk_bf16_f32 v74, v178, v210
    v_cvt_pk_bf16_f32 v75, v182, v214
    v_mfma_f32_16x16x32_bf16 v[228:231], v[92:95], v[52:55], v[60:63]
    v_cvt_pk_bf16_f32 v76, v171, v203
    v_cvt_pk_bf16_f32 v77, v175, v207
    v_cvt_pk_bf16_f32 v78, v179, v211
    v_cvt_pk_bf16_f32 v79, v183, v215
    v_mfma_f32_16x16x32_bf16 v[152:155], v[64:67], v[96:99], 0
    v_cvt_pk_bf16_f32 v80, v184, v216
    v_cvt_pk_bf16_f32 v81, v188, v220
    v_cvt_pk_bf16_f32 v82, v192, v224
    v_cvt_pk_bf16_f32 v83, v196, v228
    v_mfma_f32_16x16x32_bf16 v[156:159], v[68:71], v[100:103], 0
    v_cvt_pk_bf16_f32 v84, v185, v217
    v_cvt_pk_bf16_f32 v85, v189, v221
    v_cvt_pk_bf16_f32 v86, v193, v225
    v_cvt_pk_bf16_f32 v87, v197, v229
    v_mfma_f32_16x16x32_bf16 v[160:163], v[72:75], v[104:107], 0
    v_cvt_pk_bf16_f32 v88, v186, v218
    v_cvt_pk_bf16_f32 v89, v190, v222
    v_cvt_pk_bf16_f32 v90, v194, v226
    v_cvt_pk_bf16_f32 v91, v198, v230
    v_mfma_f32_16x16x32_bf16 v[164:167], v[76:79], v[108:111], 0
    v_cvt_pk_bf16_f32 v92, v187, v219
    v_cvt_pk_bf16_f32 v93, v191, v223
    v_cvt_pk_bf16_f32 v94, v195, v227
    v_cvt_pk_bf16_f32 v95, v199, v231
    v_mfma_f32_16x16x32_bf16 v[232:235], v[80:83], v[112:115], 0
    v_add_u32 v12, s97, v12
    v_xor_b32 v12, s94, v12
    v_mfma_f32_16x16x32_bf16 v[236:239], v[84:87], v[116:119], 0
    v_subrev_u32 v12, s94, v12
    v_and_b32 v9, 7, v12
    v_mfma_f32_16x16x32_bf16 v[240:243], v[88:91], v[120:123], 0
    v_lshlrev_b32 v9, 4, v9
    v_bfe_u32 v13, v12, 3, 1
    v_mfma_f32_16x16x32_bf16 v[244:247], v[92:95], v[124:127], 0
    v_lshl_add_u32 v9, v13, 10, v9
    v_bfe_u32 v13, v12, 4, 2
    v_cvt_pk_bf16_f32 v32, v152, v156
    v_cvt_pk_bf16_f32 v33, v160, v164
    v_cvt_pk_bf16_f32 v34, v232, v236
    s_nop 2
    v_cvt_pk_bf16_f32 v35, v240, v244
    ds_write_b128 v10, v[32:35] offset:0
    v_cvt_pk_bf16_f32 v36, v153, v157
    v_cvt_pk_bf16_f32 v37, v161, v165
    v_cvt_pk_bf16_f32 v38, v233, v237
    v_cvt_pk_bf16_f32 v39, v241, v245
    ds_write_b128 v10, v[36:39] offset:1024
    v_cvt_pk_bf16_f32 v40, v154, v158
    v_cvt_pk_bf16_f32 v41, v162, v166
    v_cvt_pk_bf16_f32 v42, v234, v238
    v_cvt_pk_bf16_f32 v43, v242, v246
    ds_write_b128 v10, v[40:43] offset:2048
    v_cvt_pk_bf16_f32 v44, v155, v159
    v_cvt_pk_bf16_f32 v45, v163, v167
    v_cvt_pk_bf16_f32 v46, v235, v239
    v_cvt_pk_bf16_f32 v47, v243, v247
    ds_write_b128 v10, v[44:47] offset:3072
    ds_read_b32 v23, v23
    ds_read_u16 v24, v24
    v_cmp_gt_u32 vcc, 32, v1
    v_mov_b32 v30, s37
    s_waitcnt lgkmcnt(0)
    s_barrier
    ds_read_b128 v[64:67], v11
    ds_read_b128 v[68:71], v11 offset:16
    ds_read_b128 v[72:75], v11 offset:8192
    ds_read_b128 v[76:79], v11 offset:8208
    v_lshlrev_b32 v24, 16, v24
    v_cndmask_b32 v23, v24, v23, vcc
    buffer_store_dword v23, v22, s[8:11], s54 offen sc1
    s_waitcnt lgkmcnt(3)
    v_mfma_f32_16x16x32_bf16 v[32:35], v[128:131], v[64:67], 0
    v_mfma_f32_16x16x32_bf16 v[36:39], v[136:139], v[64:67], 0
    s_waitcnt lgkmcnt(2)
    v_mfma_f32_16x16x32_bf16 v[32:35], v[144:147], v[68:71], v[32:35]
    v_mfma_f32_16x16x32_bf16 v[36:39], v[128:131], v[68:71], v[36:39]
    v_mfma_f32_16x16x32_bf16 v[40:43], v[132:135], v[64:67], 0
    v_mfma_f32_16x16x32_bf16 v[44:47], v[140:143], v[64:67], 0
    v_mfma_f32_16x16x32_bf16 v[40:43], v[148:151], v[68:71], v[40:43]
    v_mfma_f32_16x16x32_bf16 v[44:47], v[132:135], v[68:71], v[44:47]
    s_nop 3
    v_cvt_pk_bf16_f32 v48, v32, v36
    v_cvt_pk_bf16_f32 v49, v33, v37
    v_cvt_pk_bf16_f32 v50, v34, v38
    v_cvt_pk_bf16_f32 v51, v35, v39
    buffer_store_dwordx4 v[48:51], v18, s[8:11], s53 offen sc1
L_pg1:
    s_cbranch_execz L_ret_t
    v_cvt_pk_bf16_f32 v52, v40, v44
    v_cvt_pk_bf16_f32 v53, v41, v45
    v_cvt_pk_bf16_f32 v54, v42, v46
    v_cvt_pk_bf16_f32 v55, v43, v47
    buffer_store_dwordx4 v[52:55], v19, s[8:11], s53 offen sc1
L_ust:
    s_cmp_eq_u32 s52, 4
    s_waitcnt lgkmcnt(0)
    s_cbranch_scc0 L_a_main
    s_add_u32 s39, s53, 1048576
    v_mfma_f32_16x16x32_bf16 v[168:171], v[128:131], v[72:75], 0
    v_mfma_f32_16x16x32_bf16 v[172:175], v[136:139], v[72:75], 0
    v_mfma_f32_16x16x32_bf16 v[168:171], v[144:147], v[76:79], v[168:171]
    v_mfma_f32_16x16x32_bf16 v[172:175], v[128:131], v[76:79], v[172:175]
    v_mfma_f32_16x16x32_bf16 v[176:179], v[132:135], v[72:75], 0
    v_mfma_f32_16x16x32_bf16 v[180:183], v[140:143], v[72:75], 0
    v_mfma_f32_16x16x32_bf16 v[176:179], v[148:151], v[76:79], v[176:179]
    v_mfma_f32_16x16x32_bf16 v[180:183], v[132:135], v[76:79], v[180:183]
    s_mov_b32 exec_lo, 0x00ff00ff
    s_mov_b32 exec_hi, 0x00ff00ff
    s_nop 1
    v_cvt_pk_bf16_f32 v184, v168, v172
    v_cvt_pk_bf16_f32 v185, v169, v173
    v_cvt_pk_bf16_f32 v186, v170, v174
    v_cvt_pk_bf16_f32 v187, v171, v175
    buffer_store_dwordx4 v[184:187], v18, s[8:11], s39 offen sc1
    v_cvt_pk_bf16_f32 v188, v176, v180
    v_cvt_pk_bf16_f32 v189, v177, v181
    v_cvt_pk_bf16_f32 v190, v178, v182
    v_cvt_pk_bf16_f32 v191, v179, v183
    buffer_store_dwordx4 v[188:191], v19, s[8:11], s39 offen sc1
    s_mov_b64 exec, -1
L_a_main:
    s_cmp_eq_u32 s32, 0
    s_cbranch_scc1 L_norpl
    s_waitcnt vmcnt(8)
L_norpl:
    ds_read_b64_tr_b16 v[248:249], v7
    ds_read_b64_tr_b16 v[250:251], v7 offset:512
    v_xor_b32 v7, 64, v7
    ds_read_b64_tr_b16 v[252:253], v7
    ds_read_b64_tr_b16 v[254:255], v7 offset:512
    v_lshl_add_u32 v9, v13, 2, v9
    v_bfe_u32 v13, v12, 6, 3
    v_lshl_add_u32 v9, v13, 7, v9
    v_lshl_add_u32 v9, v4, 16, v9
    v_min_u32 v15, 1, v1
    v_lshlrev_b32 v15, 30, v15
    v_bfe_u32 v12, v1, 2, 2
    v_lshl_add_u32 v12, v4, 3, v12
    v_and_b32 v13, 1, v1
    v_bfe_u32 v14, v1, 1, 1
    v_lshl_or_b32 v13, v13, 1, v14
    v_lshlrev_b32 v13, 3, v13
    v_lshl_add_u32 v14, v12, 7, v13
    v_and_b32 v12, 2, v12
    v_lshl_add_u32 v14, v12, 4, v14
    s_waitcnt lgkmcnt(0)
    s_add_u32 s66, s57, 65536
    buffer_store_dwordx4 v[248:251], v25, s[8:11], s57 offen sc1
    buffer_store_dwordx4 v[252:255], v25, s[8:11], s66 offen sc1
    v_mov_b32 v17, v9
    v_add_u32 v18, 4096, v9
    v_mov_b32 v19, v8
    s_mov_b32 s54, 2228224
    v_cvt_f32_u32 v26, v5
    v_mul_f32 v26, s93, v26
    v_lshlrev_b32 v27, 5, v4
    v_lshl_add_u32 v27, s92, 4, v27
    v_xor_b32 v31, 16, v27
    v_cvt_f32_u32 v27, v27
    v_cvt_f32_u32 v31, v31
    v_mul_f32 v27, v26, v27
    s_lshl_b32 s66, s32, 13
    s_add_u32 m0, s66, 0
    s_lshl_b32 s67, s36, 7
    s_add_u32 s67, s67, s63
    s_add_u32 s67, s67, 0
    buffer_load_dwordx4 v20, s[12:15], s67 offen offset:0 lds
    s_add_u32 s67, s67, 27648
    buffer_load_dwordx4 v20, s[12:15], s67 offen offset:1024 lds
    s_add_u32 s67, s67, 27648
    buffer_load_dwordx4 v20, s[12:15], s67 offen offset:2048 lds
    s_add_u32 s67, s67, 27648
    buffer_load_dwordx4 v20, s[12:15], s67 offen offset:3072 lds
    v_cos_f32 v28, v27
    v_sin_f32 v29, v27
    v_add_f32 v27, v27, v26
    v_cvt_pk_bf16_f32 v96, v28, v29
    v_cos_f32 v28, v27
    v_sin_f32 v29, v27
    v_add_f32 v27, v27, v26
    v_cvt_pk_bf16_f32 v97, v28, v29
    v_cos_f32 v28, v27
    v_sin_f32 v29, v27
    v_add_f32 v27, v27, v26
    v_cvt_pk_bf16_f32 v98, v28, v29
    v_cos_f32 v28, v27
    v_sin_f32 v29, v27
    v_add_f32 v27, v27, v26
    v_cvt_pk_bf16_f32 v99, v28, v29
    v_cos_f32 v28, v27
    v_sin_f32 v29, v27
    v_add_f32 v27, v27, v26
    v_cvt_pk_bf16_f32 v100, v28, v29
    v_cos_f32 v28, v27
    v_sin_f32 v29, v27
    v_add_f32 v27, v27, v26
    v_cvt_pk_bf16_f32 v101, v28, v29
    v_cos_f32 v28, v27
    v_sin_f32 v29, v27
    v_add_f32 v27, v27, v26
    v_cvt_pk_bf16_f32 v102, v28, v29
    v_cos_f32 v28, v27
    v_sin_f32 v29, v27
    v_add_f32 v27, v27, v26
    v_cvt_pk_bf16_f32 v103, v28, v29
    v_cos_f32 v28, v27
    v_sin_f32 v29, v27
    v_add_f32 v27, v27, v26
    v_cvt_pk_bf16_f32 v104, v28, v29
    v_cos_f32 v28, v27
    v_sin_f32 v29, v27
    v_add_f32 v27, v27, v26
    v_cvt_pk_bf16_f32 v105, v28, v29
    v_cos_f32 v28, v27
    v_sin_f32 v29, v27
    v_add_f32 v27, v27, v26
    v_cvt_pk_bf16_f32 v106, v28, v29
    v_cos_f32 v28, v27
    v_sin_f32 v29, v27
    v_add_f32 v27, v27, v26
    v_cvt_pk_bf16_f32 v107, v28, v29
    v_cos_f32 v28, v27
    v_sin_f32 v29, v27
    v_add_f32 v27, v27, v26
    v_cvt_pk_bf16_f32 v108, v28, v29
    v_cos_f32 v28, v27
    v_sin_f32 v29, v27
    v_add_f32 v27, v27, v26
    v_cvt_pk_bf16_f32 v109, v28, v29
    v_cos_f32 v28, v27
    v_sin_f32 v29, v27
    v_add_f32 v27, v27, v26
    v_cvt_pk_bf16_f32 v110, v28, v29
    v_cos_f32 v28, v27
    v_sin_f32 v29, v27
    v_mul_f32 v27, v26, v31
    v_cvt_pk_bf16_f32 v111, v28, v29
    v_cos_f32 v28, v27
    v_sin_f32 v29, v27
    v_add_f32 v27, v27, v26
    v_cvt_pk_bf16_f32 v112, v28, v29
    v_cos_f32 v28, v27
    v_sin_f32 v29, v27
    v_add_f32 v27, v27, v26
    v_cvt_pk_bf16_f32 v113, v28, v29
    v_cos_f32 v28, v27
    v_sin_f32 v29, v27
    v_add_f32 v27, v27, v26
    v_cvt_pk_bf16_f32 v114, v28, v29
    v_cos_f32 v28, v27
    v_sin_f32 v29, v27
    v_add_f32 v27, v27, v26
    v_cvt_pk_bf16_f32 v115, v28, v29
    v_cos_f32 v28, v27
    v_sin_f32 v29, v27
    v_add_f32 v27, v27, v26
    v_cvt_pk_bf16_f32 v116, v28, v29
    v_cos_f32 v28, v27
    v_sin_f32 v29, v27
    v_add_f32 v27, v27, v26
    v_cvt_pk_bf16_f32 v117, v28, v29
    v_cos_f32 v28, v27
    v_sin_f32 v29, v27
    v_add_f32 v27, v27, v26
    v_cvt_pk_bf16_f32 v118, v28, v29
    v_cos_f32 v28, v27
    v_sin_f32 v29, v27
    v_add_f32 v27, v27, v26
    v_cvt_pk_bf16_f32 v119, v28, v29
    s_mov_b64 exec, 0
    s_cmp_eq_u32 s32, 0
    s_cbranch_scc1 L_pg2
    s_cmp_eq_u32 s32, 1
    s_cbranch_scc1 L_pg3
    s_cmp_eq_u32 s32, 2
    s_cbranch_scc1 L_pg4
    s_cmp_eq_u32 s32, 3
    s_cbranch_scc1 L_pg5
L_ret_w:
    s_mov_b64 exec, -1
    s_and_b32 s39, s34, 3
    s_mul_i32 s39, s39, 124
    s_mul_i32 s40, s60, 384
    s_add_u32 s39, s39, s40
    s_add_u32 s39, s39, 0x8000
    v_mov_b32 v80, v15
    s_nop 0
    v_writelane_b32 v80, s39, 1
    v_lshlrev_b32 v81, 2, v19
    s_add_u32 s43, s98, 0x8000
    s_waitcnt vmcnt(4)
    s_barrier
    buffer_store_dword v30, v80, s[8:11], s44 offen sc1
    s_lshl_b32 s66, s32, 12
    s_add_u32 m0, s66, 147456
    s_nop 0
    buffer_load_dwordx4 v6, s[4:7], s95 offen lds
    buffer_load_dwordx4 v6, s[4:7], s96 offen offset:1024 lds
    s_lshl_b32 s66, s32, 13
    s_add_u32 m0, s66, 4096
    s_lshl_b32 s67, s36, 7
    s_add_u32 s67, s67, s63
    s_add_u32 s67, s67, 114688
    buffer_load_dwordx4 v20, s[12:15], s67 offen offset:0 lds
    s_add_u32 s67, s67, 27648
    buffer_load_dwordx4 v20, s[12:15], s67 offen offset:1024 lds
    s_add_u32 s67, s67, 27648
    buffer_load_dwordx4 v20, s[12:15], s67 offen offset:2048 lds
    s_add_u32 s67, s67, 27648
    buffer_load_dwordx4 v20, s[12:15], s67 offen offset:3072 lds
    s_lshl_b32 s66, s32, 13
    s_add_u32 m0, s66, 32768
    s_lshl_b32 s67, s36, 7
    s_add_u32 s67, s67, s63
    s_add_u32 s67, s67, 0
    buffer_load_dwordx4 v21, s[16:19], s67 offen offset:0 lds
    s_add_u32 s67, s67, 27648
    buffer_load_dwordx4 v21, s[16:19], s67 offen offset:1024 lds
    s_add_u32 s67, s67, 27648
    buffer_load_dwordx4 v21, s[16:19], s67 offen offset:2048 lds
    s_add_u32 s67, s67, 27648
    buffer_load_dwordx4 v21, s[16:19], s67 offen offset:3072 lds
    s_add_u32 m0, m0, 4096
    s_add_u32 s67, s67, 31744
    buffer_load_dwordx4 v21, s[16:19], s67 offen offset:0 lds
    s_add_u32 s67, s67, 27648
    buffer_load_dwordx4 v21, s[16:19], s67 offen offset:1024 lds
    s_add_u32 s67, s67, 27648
    buffer_load_dwordx4 v21, s[16:19], s67 offen offset:2048 lds
    s_add_u32 s67, s67, 27648
    buffer_load_dwordx4 v21, s[16:19], s67 offen offset:3072 lds
    s_lshl_b32 s66, s32, 13
    s_add_u32 m0, s66, 65536
    s_lshl_b32 s67, s36, 7
    s_add_u32 s67, s67, s63
    s_add_u32 s67, s67, 917504
    buffer_load_dwordx4 v20, s[12:15], s67 offen offset:0 lds
    s_add_u32 s67, s67, 27648
    buffer_load_dwordx4 v20, s[12:15], s67 offen offset:1024 lds
    s_add_u32 s67, s67, 27648
    buffer_load_dwordx4 v20, s[12:15], s67 offen offset:2048 lds
    s_add_u32 s67, s67, 27648
    buffer_load_dwordx4 v20, s[12:15], s67 offen offset:3072 lds
    s_add_u32 m0, m0, 4096
    s_add_u32 s67, s67, 31744
    buffer_load_dwordx4 v20, s[12:15], s67 offen offset:0 lds
    s_add_u32 s67, s67, 27648
    buffer_load_dwordx4 v20, s[12:15], s67 offen offset:1024 lds
    s_add_u32 s67, s67, 27648
    buffer_load_dwordx4 v20, s[12:15], s67 offen offset:2048 lds
    s_add_u32 s67, s67, 27648
    buffer_load_dwordx4 v20, s[12:15], s67 offen offset:3072 lds
    s_lshl_b32 s66, s32, 13
    s_add_u32 m0, s66, 98304
    s_lshl_b32 s67, s36, 7
    s_add_u32 s67, s67, s63
    s_add_u32 s67, s67, 917504
    buffer_load_dwordx4 v21, s[16:19], s67 offen offset:0 lds
    s_add_u32 s67, s67, 27648
    buffer_load_dwordx4 v21, s[16:19], s67 offen offset:1024 lds
    s_add_u32 s67, s67, 27648
    buffer_load_dwordx4 v21, s[16:19], s67 offen offset:2048 lds
    s_add_u32 s67, s67, 27648
    buffer_load_dwordx4 v21, s[16:19], s67 offen offset:3072 lds
    s_add_u32 m0, m0, 4096
    s_add_u32 s67, s67, 31744
    buffer_load_dwordx4 v21, s[16:19], s67 offen offset:0 lds
    s_add_u32 s67, s67, 27648
    buffer_load_dwordx4 v21, s[16:19], s67 offen offset:1024 lds
    buffer_load_dwordx4 v[76:79], v19, s[8:11], s98 offen sc1
    v_cos_f32 v28, v27
    v_sin_f32 v29, v27
    v_add_f32 v27, v27, v26
    v_cvt_pk_bf16_f32 v120, v28, v29
    v_cos_f32 v28, v27
    v_sin_f32 v29, v27
    v_add_f32 v27, v27, v26
    v_cvt_pk_bf16_f32 v121, v28, v29
    v_cos_f32 v28, v27
    v_sin_f32 v29, v27
    v_add_f32 v27, v27, v26
    v_cvt_pk_bf16_f32 v122, v28, v29
    v_cos_f32 v28, v27
    v_sin_f32 v29, v27
    v_add_f32 v27, v27, v26
    v_cvt_pk_bf16_f32 v123, v28, v29
    v_cos_f32 v28, v27
    v_sin_f32 v29, v27
    v_add_f32 v27, v27, v26
    v_cvt_pk_bf16_f32 v124, v28, v29
    v_cos_f32 v28, v27
    v_sin_f32 v29, v27
    v_add_f32 v27, v27, v26
    v_cvt_pk_bf16_f32 v125, v28, v29
    v_cos_f32 v28, v27
    v_sin_f32 v29, v27
    v_add_f32 v27, v27, v26
    v_cvt_pk_bf16_f32 v126, v28, v29
    v_cos_f32 v28, v27
    v_sin_f32 v29, v27
    v_add_f32 v27, v27, v26
    v_cvt_pk_bf16_f32 v127, v28, v29
    s_cmp_eq_u32 s32, 0
    s_cbranch_scc1 L_ts0
    s_cmp_eq_u32 s32, 1
    s_cbranch_scc1 L_ts1
    s_cmp_eq_u32 s32, 2
    s_cbranch_scc1 L_ts2
    s_cmp_eq_u32 s32, 3
    s_cbranch_scc1 L_ts3
L_ts_ret:
    s_waitcnt vmcnt(0)
    v_xor_b32 v76, v30, v76
    v_xor_b32 v77, v30, v77
    v_xor_b32 v78, v30, v78
    v_xor_b32 v79, v30, v79
    v_or_b32 v76, v76, v77
    v_or3_b32 v76, v76, v78, v79
    v_cmp_ne_u32 vcc, 0, v76
    s_cbranch_vccnz L_p1_slow
L_p1_ok:
    buffer_load_dword v7, v16, s[8:11], s54 offen sc1
    v_bfe_u32 v29, v1, 4, 1
    v_mul_u32_u24 v29, 32832, v29
    v_add_u32 v8, v14, v29
    s_add_u32 s66, s99, 0
    buffer_load_dword v128, v17, s[8:11], s66 offen offset:0 sc1
    v_xor_b32 v9, 32, v8
    v_xor_b32 v10, 64, v8
    v_xor_b32 v11, 96, v8
    buffer_load_dword v129, v17, s[8:11], s66 offen offset:2048 sc1
    v_add_u32 v12, 131072, v2
    buffer_load_dword v130, v18, s[8:11], s66 offen offset:0 sc1
    buffer_load_dword v131, v18, s[8:11], s66 offen offset:2048 sc1
    s_add_u32 s66, s99, 8192
    buffer_load_dword v132, v17, s[8:11], s66 offen offset:0 sc1
    buffer_load_dword v133, v17, s[8:11], s66 offen offset:2048 sc1
    buffer_load_dword v134, v18, s[8:11], s66 offen offset:0 sc1
    buffer_load_dword v135, v18, s[8:11], s66 offen offset:2048 sc1
    s_add_u32 s66, s99, 16384
    buffer_load_dword v136, v17, s[8:11], s66 offen offset:0 sc1
    buffer_load_dword v137, v17, s[8:11], s66 offen offset:2048 sc1
    buffer_load_dword v138, v18, s[8:11], s66 offen offset:0 sc1
    buffer_load_dword v139, v18, s[8:11], s66 offen offset:2048 sc1
    s_add_u32 s66, s99, 24576
    buffer_load_dword v140, v17, s[8:11], s66 offen offset:0 sc1
    buffer_load_dword v141, v17, s[8:11], s66 offen offset:2048 sc1
    buffer_load_dword v142, v18, s[8:11], s66 offen offset:0 sc1
    buffer_load_dword v143, v18, s[8:11], s66 offen offset:2048 sc1
    s_lshl_b32 s41, s32, 12
    s_add_u32 s39, s41, 147456
    v_bfe_u32 v28, v3, 2, 2
    v_xor_b32 v28, v28, v4
    v_lshlrev_b32 v28, 4, v28
    v_lshl_add_u32 v28, v3, 6, v28
    v_add_u32 v28, s39, v28
    v_xor_b32 v29, 32, v28
    ds_read_b128 v[160:163], v28
    ds_read_b128 v[164:167], v29
    v_add_u32 v30, s39, v2
    v_xor_b32 v31, 4096, v30
    s_lshl2_add_u32 s43, s55, s32
    s_and_b32 s44, s34, 15
    s_lshl4_add_u32 s39, s43, s44
    s_lshl_b32 s40, s39, 7
    s_add_u32 s40, s40, 2375680
    s_lshl_b32 s39, s43, 9
    s_add_u32 s39, s39, s97
    s_lshl_b32 s39, s39, 6
    s_add_u32 s39, s39, 2621440
    v_lshl_add_u32 v74, v4, 9, v2
    v_mov_b32 v26, 0
    v_lshlrev_b32 v75, 2, v1
    s_waitcnt lgkmcnt(0)
    v_lshlrev_b32 v32, 16, v160
    v_and_b32 v33, 0xffff0000, v160
    v_lshlrev_b32 v34, 16, v161
    v_and_b32 v35, 0xffff0000, v161
    v_lshlrev_b32 v36, 16, v162
    v_and_b32 v37, 0xffff0000, v162
    v_lshlrev_b32 v38, 16, v163
    v_and_b32 v39, 0xffff0000, v163
    v_lshlrev_b32 v40, 16, v164
    v_and_b32 v41, 0xffff0000, v164
    v_lshlrev_b32 v42, 16, v165
    v_and_b32 v43, 0xffff0000, v165
    v_lshlrev_b32 v44, 16, v166
    v_and_b32 v45, 0xffff0000, v166
    v_lshlrev_b32 v46, 16, v167
    v_and_b32 v47, 0xffff0000, v167
    s_waitcnt vmcnt(12)
    ds_write_b128 v30, v[128:131] offset:0
    v_sub_f32 v32, v32, v7
    v_sub_f32 v33, v33, v7
    v_sub_f32 v34, v34, v7
    v_sub_f32 v35, v35, v7
    v_sub_f32 v36, v36, v7
    v_sub_f32 v37, v37, v7
    v_sub_f32 v38, v38, v7
    v_sub_f32 v39, v39, v7
    v_sub_f32 v40, v40, v7
    v_sub_f32 v41, v41, v7
    v_sub_f32 v42, v42, v7
    v_sub_f32 v43, v43, v7
    v_sub_f32 v44, v44, v7
    v_sub_f32 v45, v45, v7
    v_sub_f32 v46, v46, v7
    v_sub_f32 v47, v47, v7
    s_nop 1
    v_mfma_f32_32x32x16_bf16 v[32:47], v[128:131], v[96:99], v[32:47]
    s_waitcnt vmcnt(8)
    ds_write_b128 v30, v[132:135] offset:1024
    v_mfma_f32_32x32x16_bf16 v[32:47], v[132:135], v[100:103], v[32:47]
    s_waitcnt vmcnt(4)
    ds_write_b128 v30, v[136:139] offset:2048
    v_mfma_f32_32x32x16_bf16 v[32:47], v[136:139], v[104:107], v[32:47]
    s_waitcnt vmcnt(0)
    ds_write_b128 v30, v[140:143] offset:3072
    s_waitcnt lgkmcnt(0)
    s_barrier
    ds_read_b128 v[144:147], v31 offset:0
    ds_read_b128 v[148:151], v31 offset:1024
    ds_read_b128 v[152:155], v31 offset:2048
    ds_read_b128 v[156:159], v31 offset:3072
    s_add_u32 s67, s67, 27648
    buffer_load_dwordx4 v21, s[16:19], s67 offen offset:2048 lds
    s_add_u32 s67, s67, 27648
    buffer_load_dwordx4 v21, s[16:19], s67 offen offset:3072 lds
    v_mfma_f32_32x32x16_bf16 v[32:47], v[140:143], v[108:111], v[32:47]
    s_waitcnt lgkmcnt(3)
    v_mfma_f32_32x32x16_bf16 v[32:47], v[144:147], v[112:115], v[32:47]
    s_waitcnt lgkmcnt(2)
    v_mfma_f32_32x32x16_bf16 v[32:47], v[148:151], v[116:119], v[32:47]
    s_waitcnt lgkmcnt(1)
    v_mfma_f32_32x32x16_bf16 v[32:47], v[152:155], v[120:123], v[32:47]
    s_waitcnt lgkmcnt(0)
    v_mfma_f32_32x32x16_bf16 v[32:47], v[156:159], v[124:127], v[32:47]
    s_mul_i32 s56, s36, 98304
    s_add_u32 s56, s56, s41
    s_add_u32 s56, s56, 18874368
    s_mov_b32 s57, s41
    s_nop 7
    v_cvt_pk_bf16_f32 v48, v32, v33
    v_cvt_pk_bf16_f32 v49, v34, v35
    v_cvt_pk_bf16_f32 v50, v36, v37
    v_cvt_pk_bf16_f32 v51, v38, v39
    buffer_store_dwordx4 v[48:51], v74, s[8:11], s39 offen offset:0 sc1
    v_cvt_pk_bf16_f32 v52, v40, v41
    v_cvt_pk_bf16_f32 v53, v42, v43
    v_cvt_pk_bf16_f32 v54, v44, v45
    v_cvt_pk_bf16_f32 v55, v46, v47
    buffer_store_dwordx4 v[52:55], v74, s[8:11], s39 offen offset:2048 sc1
    v_dot2c_f32_bf16 v26, v48, v48
    v_dot2c_f32_bf16 v26, v49, v49
    v_dot2c_f32_bf16 v26, v50, v50
    v_dot2c_f32_bf16 v26, v51, v51
    v_dot2c_f32_bf16 v26, v52, v52
    v_dot2c_f32_bf16 v26, v53, v53
    v_dot2c_f32_bf16 v26, v54, v54
    v_dot2c_f32_bf16 v26, v55, v55
    s_nop 2
    v_mov_b32 v27, v26
    s_nop 1
    v_permlane32_swap_b32 v26, v27
    v_add_f32 v26, v26, v27
    s_mov_b32 exec_hi, 0
    buffer_store_dword v26, v75, s[8:11], s40 offen sc1
    s_mov_b64 exec, -1
    s_lshl_b32 s39, s38, 9
    s_add_u32 s58, s39, 20447232
    s_lshr_b32 s40, s36, 2
    s_lshl_b32 s40, s40, 7
    s_and_b32 s42, s36, 3
    s_lshl_b32 s42, s42, 2
    s_add_u32 s59, s58, s40
    s_add_u32 s59, s59, s42
    v_mov_b32 v30, s37
    v_add_u32 v104, 0x8000, v19
    v_and_b32 v18, 3, v1
    v_lshlrev_b32 v18, 2, v18
    v_bfe_u32 v19, v1, 2, 2
    v_lshl_add_u32 v19, v19, 7, v18
    v_add_u32 v18, s40, v18
    s_lshl_b32 s45, s38, 15
    s_add_u32 s45, s45, 2621440
    s_mov_b32 s101, s45
    s_waitcnt vmcnt(3)
    s_barrier
    s_or_b32 s39, s2, s32
    s_cbranch_scc1 L_noep
    s_mov_b32 s39, 2617344
    buffer_store_dword v30, v15, s[8:11], s39 offen sc1
L_noep:
    ds_read_b64_tr_b16 a[0:1], v8 offset:0
    ds_read_b64_tr_b16 a[2:3], v8 offset:512
    s_mul_i32 s39, s38, 114688
    s_add_u32 s39, s39, 4718592
    ds_read_b64_tr_b16 a[4:5], v9 offset:0
    ds_read_b64_tr_b16 a[6:7], v9 offset:512
    s_xor_b32 s40, s36, 0
    s_lshl_b32 s40, s40, 10
    ds_read_b64_tr_b16 a[8:9], v10 offset:0
    ds_read_b64_tr_b16 a[10:11], v10 offset:512
    s_lshl2_add_u32 s48, s40, s39
    s_sub_u32 s52, s48, s40
    ds_read_b64_tr_b16 a[12:13], v11 offset:0
    ds_read_b64_tr_b16 a[14:15], v11 offset:512
    s_add_u32 s52, s52, 65536
    s_xor_b32 s40, s36, 1
    ds_read_b64_tr_b16 a[16:17], v8 offset:2048
    ds_read_b64_tr_b16 a[18:19], v8 offset:2560
    s_lshl_b32 s40, s40, 10
    s_lshl2_add_u32 s49, s40, s39
    ds_read_b64_tr_b16 a[20:21], v9 offset:2048
    ds_read_b64_tr_b16 a[22:23], v9 offset:2560
    s_sub_u32 s53, s49, s40
    s_add_u32 s53, s53, 65536
    ds_read_b64_tr_b16 a[24:25], v10 offset:2048
    ds_read_b64_tr_b16 a[26:27], v10 offset:2560
    s_xor_b32 s40, s36, 2
    s_lshl_b32 s40, s40, 10
    s_waitcnt lgkmcnt(6)
    ds_read_b64_tr_b16 a[28:29], v11 offset:2048
    ds_read_b64_tr_b16 a[30:31], v11 offset:2560
    s_lshl2_add_u32 s50, s40, s39
    s_sub_u32 s54, s50, s40
    ds_read_b64_tr_b16 a[32:33], v8 offset:4096
    ds_read_b64_tr_b16 a[34:35], v8 offset:4608
    s_add_u32 s54, s54, 65536
    s_xor_b32 s40, s36, 3
    ds_read_b64_tr_b16 a[36:37], v9 offset:4096
    ds_read_b64_tr_b16 a[38:39], v9 offset:4608
    s_lshl_b32 s40, s40, 10
    s_lshl2_add_u32 s51, s40, s39
    ds_read_b64_tr_b16 a[40:41], v10 offset:4096
    ds_read_b64_tr_b16 a[42:43], v10 offset:4608
    s_sub_u32 s55, s51, s40
    s_add_u32 s55, s55, 65536
    s_waitcnt lgkmcnt(6)
    ds_read_b64_tr_b16 a[44:45], v11 offset:4096
    ds_read_b64_tr_b16 a[46:47], v11 offset:4608
    s_lshl_b32 s65, s38, 4
    s_add_u32 s65, s65, s36
    ds_read_b64_tr_b16 a[48:49], v8 offset:6144
    ds_read_b64_tr_b16 a[50:51], v8 offset:6656
    s_mul_i32 s65, s65, 6144
    s_add_u32 s65, s65, 12582912
    ds_read_b64_tr_b16 a[52:53], v9 offset:6144
    ds_read_b64_tr_b16 a[54:55], v9 offset:6656
    s_add_u32 s3, s65, 4096
    v_mov_b32 v22, -1
    ds_read_b64_tr_b16 a[56:57], v10 offset:6144
    ds_read_b64_tr_b16 a[58:59], v10 offset:6656
    v_mov_b32 v23, -1
    v_mov_b32 v24, -1
    s_waitcnt lgkmcnt(6)
    ds_read_b64_tr_b16 a[60:61], v11 offset:6144
    ds_read_b64_tr_b16 a[62:63], v11 offset:6656
    v_mov_b32 v25, -1
    s_sub_u32 s39, 32, s35
    ds_read_b64_tr_b16 a[64:65], v8 offset:8192
    ds_read_b64_tr_b16 a[66:67], v8 offset:8704
    s_cmp_eq_u32 s35, 0
    s_cselect_b32 s39, 16, s39
    ds_read_b64_tr_b16 a[68:69], v9 offset:8192
    ds_read_b64_tr_b16 a[70:71], v9 offset:8704
    s_cmp_lt_u32 s32, 2
    s_cselect_b32 s39, s35, s39
    ds_read_b64_tr_b16 a[72:73], v10 offset:8192
    ds_read_b64_tr_b16 a[74:75], v10 offset:8704
    s_and_b32 s44, s32, 1
    s_lshl_b32 s44, s44, 10
    s_waitcnt lgkmcnt(6)
    ds_read_b64_tr_b16 a[76:77], v11 offset:8192
    ds_read_b64_tr_b16 a[78:79], v11 offset:8704
    s_add_u32 s39, s39, s44
    v_lshl_add_u32 v5, v3, 5, s39
    ds_read_b64_tr_b16 a[80:81], v8 offset:10240
    ds_read_b64_tr_b16 a[82:83], v8 offset:10752
    v_lshlrev_b32 v7, 10, v5
    ds_read_b64_tr_b16 a[84:85], v9 offset:10240
    ds_read_b64_tr_b16 a[86:87], v9 offset:10752
    v_and_b32 v17, 0xfc00, v7
    ds_read_b64_tr_b16 a[88:89], v10 offset:10240
    ds_read_b64_tr_b16 a[90:91], v10 offset:10752
    v_lshrrev_b32 v26, 6, v5
    s_waitcnt lgkmcnt(6)
    ds_read_b64_tr_b16 a[92:93], v11 offset:10240
    ds_read_b64_tr_b16 a[94:95], v11 offset:10752
    v_lshl_add_u32 v17, v26, 2, v17
    ds_read_b64_tr_b16 a[96:97], v8 offset:12288
    ds_read_b64_tr_b16 a[98:99], v8 offset:12800
    s_mov_b32 s44, 2228224
    ds_read_b64_tr_b16 a[100:101], v9 offset:12288
    ds_read_b64_tr_b16 a[102:103], v9 offset:12800
    s_lshl_b32 s46, s38, 11
    ds_read_b64_tr_b16 a[104:105], v10 offset:12288
    ds_read_b64_tr_b16 a[106:107], v10 offset:12800
    s_add_u32 s46, s46, 2375680
    s_waitcnt lgkmcnt(6)
    ds_read_b64_tr_b16 a[108:109], v11 offset:12288
    ds_read_b64_tr_b16 a[110:111], v11 offset:12800
    v_lshlrev_b32 v16, 2, v3
    ds_read_b64_tr_b16 a[112:113], v8 offset:14336
    ds_read_b64_tr_b16 a[114:115], v8 offset:14848
    v_lshl_add_u32 v16, v4, 10, v16
    ds_read_b64_tr_b16 a[116:117], v9 offset:14336
    ds_read_b64_tr_b16 a[118:119], v9 offset:14848
    v_lshrrev_b32 v26, 4, v1
    ds_read_b64_tr_b16 a[120:121], v10 offset:14336
    ds_read_b64_tr_b16 a[122:123], v10 offset:14848
    v_and_b32 v27, 15, v1
    s_waitcnt lgkmcnt(6)
    ds_read_b64_tr_b16 a[124:125], v11 offset:14336
    ds_read_b64_tr_b16 a[126:127], v11 offset:14848
    v_lshlrev_b32 v28, 2, v26
    ds_read_b64_tr_b16 a[128:129], v8 offset:16384
    ds_read_b64_tr_b16 a[130:131], v8 offset:16896
    v_xor_b32 v27, v27, v28
    ds_read_b64_tr_b16 a[132:133], v9 offset:16384
    ds_read_b64_tr_b16 a[134:135], v9 offset:16896
    v_lshlrev_b32 v27, 4, v27
    buffer_load_dwordx4 v[128:131], v2, s[8:11], s45 offen offset:0 sc1
    buffer_load_dwordx4 v[132:135], v2, s[8:11], s45 offen offset:1024 sc1
    buffer_load_dwordx4 v[136:139], v2, s[8:11], s45 offen offset:2048 sc1
    buffer_load_dwordx4 v[140:143], v2, s[8:11], s45 offen offset:3072 sc1
    s_add_u32 s45, s45, 4096
    buffer_load_dwordx4 v[144:147], v2, s[8:11], s45 offen offset:0 sc1
    buffer_load_dwordx4 v[148:151], v2, s[8:11], s45 offen offset:1024 sc1
    buffer_load_dwordx4 v[152:155], v2, s[8:11], s45 offen offset:2048 sc1
    buffer_load_dwordx4 v[156:159], v2, s[8:11], s45 offen offset:3072 sc1
    s_add_u32 s45, s45, 4096
    ds_read_b64_tr_b16 a[136:137], v10 offset:16384
    ds_read_b64_tr_b16 a[138:139], v10 offset:16896
    v_lshl_add_u32 v13, v26, 10, v27
    s_waitcnt lgkmcnt(6)
    ds_read_b64_tr_b16 a[140:141], v11 offset:16384
    ds_read_b64_tr_b16 a[142:143], v11 offset:16896
    s_mul_i32 s39, s38, 114688
    ds_read_b64_tr_b16 a[144:145], v8 offset:18432
    ds_read_b64_tr_b16 a[146:147], v8 offset:18944
    s_add_u32 s39, s39, 4718592
    ds_read_b64_tr_b16 a[148:149], v9 offset:18432
    ds_read_b64_tr_b16 a[150:151], v9 offset:18944
    s_lshl_b32 s39, s39, 4
    ds_read_b64_tr_b16 a[152:153], v10 offset:18432
    ds_read_b64_tr_b16 a[154:155], v10 offset:18944
    s_lshl_b32 s40, s32, 12
    s_waitcnt lgkmcnt(6)
    ds_read_b64_tr_b16 a[156:157], v11 offset:18432
    ds_read_b64_tr_b16 a[158:159], v11 offset:18944
    s_sub_u32 s40, s40, s39
    ds_read_b64_tr_b16 a[160:161], v8 offset:20480
    ds_read_b64_tr_b16 a[162:163], v8 offset:20992
    s_and_b32 s39, s36, 3
    ds_read_b64_tr_b16 a[164:165], v9 offset:20480
    ds_read_b64_tr_b16 a[166:167], v9 offset:20992
    s_lshl_b32 s39, s39, 8
    ds_read_b64_tr_b16 a[168:169], v10 offset:20480
    ds_read_b64_tr_b16 a[170:171], v10 offset:20992
    s_add_u32 s40, s40, s39
    s_waitcnt lgkmcnt(6)
    ds_read_b64_tr_b16 a[172:173], v11 offset:20480
    ds_read_b64_tr_b16 a[174:175], v11 offset:20992
    s_add_u32 s41, s40, 16384
L_pg2:
    s_cbranch_execz L_ret_w
    ds_read_b64_tr_b16 a[176:177], v8 offset:22528
    ds_read_b64_tr_b16 a[178:179], v8 offset:23040
    s_add_u32 s42, s40, 32768
    ds_read_b64_tr_b16 a[180:181], v9 offset:22528
    ds_read_b64_tr_b16 a[182:183], v9 offset:23040
    s_add_u32 s43, s40, 49152
    s_waitcnt vmcnt(4)
    v_max3_u32 v31, v128, v132, v136
    v_max3_u32 v31, v31, v140, v140
    v_cmp_eq_u32 vcc, -1, v31
    s_cbranch_vccnz L_ag0_slow
L_ag0_ok:
    v_mfma_f32_32x32x16_bf16 v[32:47], a[0:3], v[128:131], 0
    buffer_load_dwordx4 v[160:163], v2, s[8:11], s45 offen offset:0 sc1
    ds_read_b64_tr_b16 a[184:185], v10 offset:22528
    ds_read_b64_tr_b16 a[186:187], v10 offset:23040
    v_mfma_f32_32x32x16_bf16 v[48:63], a[4:7], v[128:131], 0
    buffer_load_dwordx4 v[164:167], v2, s[8:11], s45 offen offset:1024 sc1
    s_waitcnt lgkmcnt(6)
    ds_read_b64_tr_b16 a[188:189], v11 offset:22528
    ds_read_b64_tr_b16 a[190:191], v11 offset:23040
    v_mfma_f32_32x32x16_bf16 v[64:79], a[8:11], v[128:131], 0
    buffer_load_dwordx4 v[168:171], v2, s[8:11], s45 offen offset:2048 sc1
    ds_read_b64_tr_b16 a[192:193], v8 offset:24576
    ds_read_b64_tr_b16 a[194:195], v8 offset:25088
    ds_read_b64_tr_b16 a[196:197], v9 offset:24576
    ds_read_b64_tr_b16 a[198:199], v9 offset:25088
    v_mfma_f32_32x32x16_bf16 v[80:95], a[12:15], v[128:131], 0
    buffer_load_dwordx4 v[172:175], v2, s[8:11], s45 offen offset:3072 sc1
    s_add_u32 s45, s45, 4096
    ds_read_b64_tr_b16 a[200:201], v10 offset:24576
    ds_read_b64_tr_b16 a[202:203], v10 offset:25088
    v_mfma_f32_32x32x16_bf16 v[32:47], a[16:19], v[132:135], v[32:47]
    s_waitcnt lgkmcnt(6)
    ds_read_b64_tr_b16 a[204:205], v11 offset:24576
    ds_read_b64_tr_b16 a[206:207], v11 offset:25088
    ds_read_b64_tr_b16 a[0:1], v8 offset:26624
    ds_read_b64_tr_b16 a[2:3], v8 offset:27136
    v_mfma_f32_32x32x16_bf16 v[48:63], a[20:23], v[132:135], v[48:63]
    buffer_load_dwordx4 v[176:179], v2, s[8:11], s45 offen offset:0 sc1
    ds_read_b64_tr_b16 a[4:5], v9 offset:26624
    ds_read_b64_tr_b16 a[6:7], v9 offset:27136
    ds_read_b64_tr_b16 a[8:9], v10 offset:26624
    ds_read_b64_tr_b16 a[10:11], v10 offset:27136
    v_mfma_f32_32x32x16_bf16 v[64:79], a[24:27], v[132:135], v[64:79]
    s_waitcnt lgkmcnt(6)
    ds_read_b64_tr_b16 a[12:13], v11 offset:26624
    ds_read_b64_tr_b16 a[14:15], v11 offset:27136
    v_mfma_f32_32x32x16_bf16 v[80:95], a[28:31], v[132:135], v[80:95]
    buffer_load_dwordx4 v[180:183], v2, s[8:11], s45 offen offset:1024 sc1
    ds_read_b64_tr_b16 a[16:17], v8 offset:28672
    ds_read_b64_tr_b16 a[18:19], v8 offset:29184
    ds_read_b64_tr_b16 a[20:21], v9 offset:28672
    ds_read_b64_tr_b16 a[22:23], v9 offset:29184
    v_mfma_f32_32x32x16_bf16 v[32:47], a[32:35], v[136:139], v[32:47]
    buffer_load_dwordx4 v[184:187], v2, s[8:11], s45 offen offset:2048 sc1
    ds_read_b64_tr_b16 a[24:25], v10 offset:28672
    ds_read_b64_tr_b16 a[26:27], v10 offset:29184
    v_mfma_f32_32x32x16_bf16 v[48:63], a[36:39], v[136:139], v[48:63]
    s_waitcnt lgkmcnt(6)
    ds_read_b64_tr_b16 a[28:29], v11 offset:28672
    ds_read_b64_tr_b16 a[30:31], v11 offset:29184
    v_mfma_f32_32x32x16_bf16 v[64:79], a[40:43], v[136:139], v[64:79]
    buffer_load_dwordx4 v[188:191], v2, s[8:11], s45 offen offset:3072 sc1
    s_add_u32 s45, s45, 4096
    ds_read_b64_tr_b16 a[32:33], v8 offset:30720
    ds_read_b64_tr_b16 a[34:35], v8 offset:31232
    v_mfma_f32_32x32x16_bf16 v[80:95], a[44:47], v[136:139], v[80:95]
    ds_read_b64_tr_b16 a[36:37], v9 offset:30720
    ds_read_b64_tr_b16 a[38:39], v9 offset:31232
    v_mfma_f32_32x32x16_bf16 v[32:47], a[48:51], v[140:143], v[32:47]
    s_waitcnt vmcnt(8)
    v_max3_u32 v31, v144, v148, v152
    v_max3_u32 v31, v31, v156, v156
    v_cmp_eq_u32 vcc, -1, v31
    buffer_load_dwordx4 v[192:195], v2, s[8:11], s45 offen offset:0 sc1
    v_mfma_f32_32x32x16_bf16 v[48:63], a[52:55], v[140:143], v[48:63]
    s_cbranch_vccnz L_ag1_slow
L_ag1_ok:
    ds_read_b64_tr_b16 a[40:41], v10 offset:30720
    ds_read_b64_tr_b16 a[42:43], v10 offset:31232
    s_waitcnt lgkmcnt(6)
    ds_read_b64_tr_b16 a[44:45], v11 offset:30720
    ds_read_b64_tr_b16 a[46:47], v11 offset:31232
    v_mfma_f32_32x32x16_bf16 v[64:79], a[56:59], v[140:143], v[64:79]
    buffer_load_dwordx4 v[196:199], v2, s[8:11], s45 offen offset:1024 sc1
    v_add_u32 v8, 0x10000, v8
    ds_read_b64_tr_b16 a[48:49], v8 offset:0
    ds_read_b64_tr_b16 a[50:51], v8 offset:512
    v_mfma_f32_32x32x16_bf16 v[80:95], a[60:63], v[140:143], v[80:95]
    v_add_u32 v9, 0x10000, v9
    ds_read_b64_tr_b16 a[52:53], v9 offset:0
    ds_read_b64_tr_b16 a[54:55], v9 offset:512
    v_mfma_f32_32x32x16_bf16 v[32:47], a[64:67], v[144:147], v[32:47]
    buffer_load_dwordx4 v[200:203], v2, s[8:11], s45 offen offset:2048 sc1
    v_add_u32 v10, 0x10000, v10
    ds_read_b64_tr_b16 a[56:57], v10 offset:0
    ds_read_b64_tr_b16 a[58:59], v10 offset:512
    v_mfma_f32_32x32x16_bf16 v[48:63], a[68:71], v[144:147], v[48:63]
    s_waitcnt lgkmcnt(6)
    v_add_u32 v11, 0x10000, v11
    ds_read_b64_tr_b16 a[60:61], v11 offset:0
    ds_read_b64_tr_b16 a[62:63], v11 offset:512
    v_mfma_f32_32x32x16_bf16 v[64:79], a[72:75], v[144:147], v[64:79]
    buffer_load_dwordx4 v[204:207], v2, s[8:11], s45 offen offset:3072 sc1
    s_add_u32 s45, s45, 4096
    ds_read_b64_tr_b16 a[64:65], v8 offset:2048
    ds_read_b64_tr_b16 a[66:67], v8 offset:2560
    v_mfma_f32_32x32x16_bf16 v[80:95], a[76:79], v[144:147], v[80:95]
    ds_read_b64_tr_b16 a[68:69], v8 offset:4096
    ds_read_b64_tr_b16 a[70:71], v8 offset:4608
    v_mfma_f32_32x32x16_bf16 v[32:47], a[80:83], v[148:151], v[32:47]
    buffer_load_dwordx4 v[208:211], v2, s[8:11], s45 offen offset:0 sc1
    ds_read_b64_tr_b16 a[72:73], v8 offset:6144
    ds_read_b64_tr_b16 a[74:75], v8 offset:6656
    v_mfma_f32_32x32x16_bf16 v[48:63], a[84:87], v[148:151], v[48:63]
    s_waitcnt lgkmcnt(6)
    ds_read_b64_tr_b16 a[76:77], v8 offset:8192
    ds_read_b64_tr_b16 a[78:79], v8 offset:8704
    v_mfma_f32_32x32x16_bf16 v[64:79], a[88:91], v[148:151], v[64:79]
    buffer_load_dwordx4 v[212:215], v2, s[8:11], s45 offen offset:1024 sc1
    ds_read_b64_tr_b16 a[80:81], v8 offset:10240
    ds_read_b64_tr_b16 a[82:83], v8 offset:10752
    v_mfma_f32_32x32x16_bf16 v[80:95], a[92:95], v[148:151], v[80:95]
    ds_read_b64_tr_b16 a[84:85], v8 offset:12288
    ds_read_b64_tr_b16 a[86:87], v8 offset:12800
    v_mfma_f32_32x32x16_bf16 v[32:47], a[96:99], v[152:155], v[32:47]
    buffer_load_dwordx4 v[216:219], v2, s[8:11], s45 offen offset:2048 sc1
    ds_read_b64_tr_b16 a[88:89], v8 offset:14336
    ds_read_b64_tr_b16 a[90:91], v8 offset:14848
    v_mfma_f32_32x32x16_bf16 v[48:63], a[100:103], v[152:155], v[48:63]
    s_waitcnt lgkmcnt(6)
    ds_read_b64_tr_b16 a[92:93], v8 offset:16384
    ds_read_b64_tr_b16 a[94:95], v8 offset:16896
    v_mfma_f32_32x32x16_bf16 v[64:79], a[104:107], v[152:155], v[64:79]
    buffer_load_dwordx4 v[220:223], v2, s[8:11], s45 offen offset:3072 sc1
    s_add_u32 s45, s45, 4096
    ds_read_b64_tr_b16 a[96:97], v8 offset:18432
    ds_read_b64_tr_b16 a[98:99], v8 offset:18944
    v_mfma_f32_32x32x16_bf16 v[80:95], a[108:111], v[152:155], v[80:95]
    ds_read_b64_tr_b16 a[100:101], v8 offset:20480
    ds_read_b64_tr_b16 a[102:103], v8 offset:20992
    v_mfma_f32_32x32x16_bf16 v[32:47], a[112:115], v[156:159], v[32:47]
    s_waitcnt vmcnt(12)
    v_max3_u32 v31, v160, v164, v168
    v_max3_u32 v31, v31, v172, v172
    v_cmp_eq_u32 vcc, -1, v31
    buffer_load_dwordx4 v[224:227], v2, s[8:11], s45 offen offset:0 sc1
    v_mfma_f32_32x32x16_bf16 v[48:63], a[116:119], v[156:159], v[48:63]
    s_cbranch_vccnz L_ag2_slow
L_ag2_ok:
    ds_read_b64_tr_b16 a[104:105], v8 offset:22528
    ds_read_b64_tr_b16 a[106:107], v8 offset:23040
    s_waitcnt lgkmcnt(6)
    ds_read_b64_tr_b16 a[108:109], v8 offset:24576
    ds_read_b64_tr_b16 a[110:111], v8 offset:25088
    v_mfma_f32_32x32x16_bf16 v[64:79], a[120:123], v[156:159], v[64:79]
    buffer_store_dwordx4 v[22:25], v2, s[8:11], s48 offen offset:2048 sc1
    v_mfma_f32_32x32x16_bf16 v[80:95], a[124:127], v[156:159], v[80:95]
    ds_read_b64_tr_b16 a[112:113], v8 offset:26624
    ds_read_b64_tr_b16 a[114:115], v8 offset:27136
    ds_read_b64_tr_b16 a[116:117], v8 offset:28672
    ds_read_b64_tr_b16 a[118:119], v8 offset:29184
    v_mfma_f32_32x32x16_bf16 v[32:47], a[128:131], v[160:163], v[32:47]
    buffer_store_dwordx4 v[22:25], v2, s[8:11], s48 offen offset:3072 sc1
    v_mfma_f32_32x32x16_bf16 v[48:63], a[132:135], v[160:163], v[48:63]
    ds_read_b64_tr_b16 a[120:121], v8 offset:30720
    ds_read_b64_tr_b16 a[122:123], v8 offset:31232
    v_mfma_f32_32x32x16_bf16 v[64:79], a[136:139], v[160:163], v[64:79]
    buffer_store_dwordx4 v[22:25], v2, s[8:11], s52 offen offset:0 sc1
    v_mfma_f32_32x32x16_bf16 v[80:95], a[140:143], v[160:163], v[80:95]
    s_waitcnt lgkmcnt(6)
    ds_read_b64_tr_b16 a[124:125], v9 offset:2048
    ds_read_b64_tr_b16 a[126:127], v9 offset:2560
    ds_read_b64_tr_b16 a[128:129], v9 offset:4096
    ds_read_b64_tr_b16 a[130:131], v9 offset:4608
    v_mfma_f32_32x32x16_bf16 v[32:47], a[144:147], v[164:167], v[32:47]
    buffer_store_dwordx4 v[22:25], v2, s[8:11], s52 offen offset:1024 sc1
    v_mfma_f32_32x32x16_bf16 v[48:63], a[148:151], v[164:167], v[48:63]
    ds_read_b64_tr_b16 a[132:133], v9 offset:6144
    ds_read_b64_tr_b16 a[134:135], v9 offset:6656
    ds_read_b64_tr_b16 a[136:137], v9 offset:8192
    ds_read_b64_tr_b16 a[138:139], v9 offset:8704
    v_mfma_f32_32x32x16_bf16 v[64:79], a[152:155], v[164:167], v[64:79]
    buffer_store_dwordx4 v[22:25], v2, s[8:11], s52 offen offset:2048 sc1
    v_mfma_f32_32x32x16_bf16 v[80:95], a[156:159], v[164:167], v[80:95]
    s_waitcnt lgkmcnt(6)
    ds_read_b64_tr_b16 a[140:141], v9 offset:10240
    ds_read_b64_tr_b16 a[142:143], v9 offset:10752
    v_mfma_f32_32x32x16_bf16 v[32:47], a[160:163], v[168:171], v[32:47]
    buffer_load_dwordx4 v[228:231], v2, s[8:11], s45 offen offset:1024 sc1
    ds_read_b64_tr_b16 a[144:145], v9 offset:12288
    ds_read_b64_tr_b16 a[146:147], v9 offset:12800
    ds_read_b64_tr_b16 a[148:149], v9 offset:14336
    ds_read_b64_tr_b16 a[150:151], v9 offset:14848
    v_mfma_f32_32x32x16_bf16 v[48:63], a[164:167], v[168:171], v[48:63]
    s_barrier
    buffer_load_dwordx4 v[232:235], v2, s[8:11], s45 offen offset:2048 sc1
    ds_read_b64_tr_b16 a[152:153], v9 offset:16384
    ds_read_b64_tr_b16 a[154:155], v9 offset:16896
    v_mfma_f32_32x32x16_bf16 v[64:79], a[168:171], v[168:171], v[64:79]
    s_lshr_b32 s98, s36, 3
    s_mul_i32 s99, s98, -393088
    s_add_u32 s96, s41, s99
    s_add_u32 s97, s42, s99
    s_mul_i32 s99, s98, -49152
    s_add_u32 s99, s99, 24576
    v_mfma_f32_32x32x16_bf16 v[80:95], a[172:175], v[168:171], v[80:95]
    buffer_load_dwordx4 v[236:239], v2, s[8:11], s45 offen offset:3072 sc1
    s_add_u32 s45, s45, 4096
    s_add_u32 s92, s52, s99
    s_add_u32 s93, s53, s99
    s_add_u32 s94, s54, s99
    v_mfma_f32_32x32x16_bf16 v[32:47], a[176:179], v[172:175], v[32:47]
    s_waitcnt vmcnt(17)
    v_max3_u32 v31, v176, v180, v184
    v_max3_u32 v31, v31, v188, v188
    v_cmp_eq_u32 vcc, -1, v31
    s_add_u32 s95, s55, s99
    v_mfma_f32_32x32x16_bf16 v[48:63], a[180:183], v[172:175], v[48:63]
    s_cbranch_vccnz L_ag3_slow
L_ag3_ok:
    buffer_load_dwordx4 v[240:243], v2, s[8:11], s45 offen offset:0 sc1
    v_bfe_u32 v26, v13, 7, 1
    v_mul_u32_u24 v26, 393088, v26
    v_add_u32 v20, v13, v26
    v_mfma_f32_32x32x16_bf16 v[64:79], a[184:187], v[172:175], v[64:79]
    v_bfe_u32 v26, v1, 2, 1
    v_lshlrev_b32 v19, 8, v26
    v_xor_b32 v19, v19, v18
    v_xor_b32 v26, 1, v26
    v_mul_u32_u24 v26, 0, v26
    v_add_u32 v19, v19, v26
    v_mfma_f32_32x32x16_bf16 v[80:95], a[188:191], v[172:175], v[80:95]
    buffer_load_dwordx4 v[244:247], v2, s[8:11], s45 offen offset:1024 sc1
    s_waitcnt lgkmcnt(6)
    ds_read_b64_tr_b16 a[156:157], v9 offset:18432
    ds_read_b64_tr_b16 a[158:159], v9 offset:18944
    v_mfma_f32_32x32x16_bf16 v[32:47], a[192:195], v[176:179], v[32:47]
    ds_read_b64_tr_b16 a[160:161], v9 offset:20480
    ds_read_b64_tr_b16 a[162:163], v9 offset:20992
    v_mfma_f32_32x32x16_bf16 v[48:63], a[196:199], v[176:179], v[48:63]
    buffer_load_dwordx4 v[248:251], v2, s[8:11], s45 offen offset:2048 sc1
    ds_read_b64_tr_b16 a[164:165], v9 offset:22528
    ds_read_b64_tr_b16 a[166:167], v9 offset:23040
    ds_read_b64_tr_b16 a[168:169], v9 offset:24576
    ds_read_b64_tr_b16 a[170:171], v9 offset:25088
    v_mfma_f32_32x32x16_bf16 v[64:79], a[200:203], v[176:179], v[64:79]
    s_waitcnt lgkmcnt(6)
    ds_read_b64_tr_b16 a[172:173], v9 offset:26624
    ds_read_b64_tr_b16 a[174:175], v9 offset:27136
    ds_read_b64_tr_b16 a[176:177], v9 offset:28672
    ds_read_b64_tr_b16 a[178:179], v9 offset:29184
    v_mfma_f32_32x32x16_bf16 v[80:95], a[204:207], v[176:179], v[80:95]
    buffer_load_dwordx4 v[252:255], v2, s[8:11], s45 offen offset:3072 sc1
    s_add_u32 s45, s45, 4096
    ds_read_b64_tr_b16 a[180:181], v9 offset:30720
    ds_read_b64_tr_b16 a[182:183], v9 offset:31232
    v_mfma_f32_32x32x16_bf16 v[32:47], a[0:3], v[180:183], v[32:47]
    ds_read_b64_tr_b16 a[184:185], v10 offset:2048
    ds_read_b64_tr_b16 a[186:187], v10 offset:2560
    s_waitcnt lgkmcnt(6)
    ds_read_b64_tr_b16 a[188:189], v10 offset:4096
    ds_read_b64_tr_b16 a[190:191], v10 offset:4608
    v_mfma_f32_32x32x16_bf16 v[48:63], a[4:7], v[180:183], v[48:63]
    buffer_load_dword v120, v16, s[8:11], s46 offen offset:0 sc1
    ds_read_b64_tr_b16 a[192:193], v10 offset:6144
    ds_read_b64_tr_b16 a[194:195], v10 offset:6656
    ds_read_b64_tr_b16 a[196:197], v10 offset:8192
    ds_read_b64_tr_b16 a[198:199], v10 offset:8704
    v_mfma_f32_32x32x16_bf16 v[64:79], a[8:11], v[180:183], v[64:79]
    buffer_load_dword v121, v16, s[8:11], s46 offen offset:128 sc1
    ds_read_b64_tr_b16 a[200:201], v10 offset:10240
    ds_read_b64_tr_b16 a[202:203], v10 offset:10752
    v_mfma_f32_32x32x16_bf16 v[80:95], a[12:15], v[180:183], v[80:95]
    s_waitcnt lgkmcnt(6)
    ds_read_b64_tr_b16 a[204:205], v10 offset:12288
    ds_read_b64_tr_b16 a[206:207], v10 offset:12800
    ds_read_b64_tr_b16 a[0:1], v10 offset:14336
    ds_read_b64_tr_b16 a[2:3], v10 offset:14848
    v_mfma_f32_32x32x16_bf16 v[32:47], a[16:19], v[184:187], v[32:47]
    buffer_load_dword v122, v16, s[8:11], s46 offen offset:256 sc1
    ds_read_b64_tr_b16 a[4:5], v10 offset:16384
    ds_read_b64_tr_b16 a[6:7], v10 offset:16896
    ds_read_b64_tr_b16 a[8:9], v10 offset:18432
    ds_read_b64_tr_b16 a[10:11], v10 offset:18944
    v_mfma_f32_32x32x16_bf16 v[48:63], a[20:23], v[184:187], v[48:63]
    buffer_load_dword v123, v16, s[8:11], s46 offen offset:384 sc1
    s_waitcnt lgkmcnt(6)
    ds_read_b64_tr_b16 a[12:13], v10 offset:20480
    ds_read_b64_tr_b16 a[14:15], v10 offset:20992
    v_mfma_f32_32x32x16_bf16 v[64:79], a[24:27], v[184:187], v[64:79]
    buffer_load_dword v124, v16, s[8:11], s46 offen offset:512 sc1
    ds_read_b64_tr_b16 a[16:17], v10 offset:22528
    ds_read_b64_tr_b16 a[18:19], v10 offset:23040
    v_mfma_f32_32x32x16_bf16 v[80:95], a[28:31], v[184:187], v[80:95]
    buffer_load_dword v125, v16, s[8:11], s46 offen offset:640 sc1
    ds_read_b64_tr_b16 a[20:21], v10 offset:24576
    ds_read_b64_tr_b16 a[22:23], v10 offset:25088
    v_mfma_f32_32x32x16_bf16 v[32:47], a[32:35], v[188:191], v[32:47]
    s_waitcnt vmcnt(23)
    v_max3_u32 v31, v192, v196, v200
    v_max3_u32 v31, v31, v204, v204
    v_cmp_eq_u32 vcc, -1, v31
    buffer_load_dword v126, v16, s[8:11], s46 offen offset:768 sc1
    v_mfma_f32_32x32x16_bf16 v[48:63], a[36:39], v[188:191], v[48:63]
    s_cbranch_vccnz L_ag4_slow
L_ag4_ok:
    ds_read_b64_tr_b16 a[24:25], v10 offset:26624
    ds_read_b64_tr_b16 a[26:27], v10 offset:27136
    s_waitcnt lgkmcnt(6)
    ds_read_b64_tr_b16 a[28:29], v10 offset:28672
    ds_read_b64_tr_b16 a[30:31], v10 offset:29184
    v_mfma_f32_32x32x16_bf16 v[64:79], a[40:43], v[188:191], v[64:79]
    buffer_load_dword v127, v16, s[8:11], s46 offen offset:896 sc1
    ds_read_b64_tr_b16 a[32:33], v10 offset:30720
    ds_read_b64_tr_b16 a[34:35], v10 offset:31232
    v_mfma_f32_32x32x16_bf16 v[80:95], a[44:47], v[188:191], v[80:95]
    buffer_load_dword v6, v17, s[8:11], s44 offen offset:128 sc1
    ds_read_b64_tr_b16 a[36:37], v11 offset:2048
    ds_read_b64_tr_b16 a[38:39], v11 offset:2560
    v_mfma_f32_32x32x16_bf16 v[32:47], a[48:51], v[192:195], v[32:47]
    s_add_u32 m0, s57, 131072
    s_add_u32 s67, s56, 0
    buffer_load_dwordx4 v2, s[8:11], s67 offen offset:0 sc1 lds
    ds_read_b64_tr_b16 a[40:41], v11 offset:4096
    ds_read_b64_tr_b16 a[42:43], v11 offset:4608
    v_mfma_f32_32x32x16_bf16 v[48:63], a[52:55], v[192:195], v[48:63]
    s_waitcnt lgkmcnt(6)
    ds_read_b64_tr_b16 a[44:45], v11 offset:6144
    ds_read_b64_tr_b16 a[46:47], v11 offset:6656
    v_mfma_f32_32x32x16_bf16 v[64:79], a[56:59], v[192:195], v[64:79]
    buffer_load_dwordx4 v2, s[8:11], s67 offen offset:1024 sc1 lds
    ds_read_b64_tr_b16 a[48:49], v11 offset:8192
    ds_read_b64_tr_b16 a[50:51], v11 offset:8704
    v_mfma_f32_32x32x16_bf16 v[80:95], a[60:63], v[192:195], v[80:95]
    s_waitcnt vmcnt(24)
    v_max3_u32 v31, v208, v212, v216
    v_max3_u32 v31, v31, v220, v220
    v_cmp_eq_u32 vcc, -1, v31
    v_mfma_f32_32x32x16_bf16 v[32:47], a[64:67], v[196:199], v[32:47]
    s_cbranch_vccnz L_ag5_slow
L_ag5_ok:
    buffer_load_dwordx4 v2, s[8:11], s67 offen offset:2048 sc1 lds
    ds_read_b64_tr_b16 a[52:53], v11 offset:10240
    ds_read_b64_tr_b16 a[54:55], v11 offset:10752
    v_mfma_f32_32x32x16_bf16 v[32:47], a[68:71], v[200:203], v[32:47]
    ds_read_b64_tr_b16 a[56:57], v11 offset:12288
    ds_read_b64_tr_b16 a[58:59], v11 offset:12800
    v_mfma_f32_32x32x16_bf16 v[32:47], a[72:75], v[204:207], v[32:47]
    buffer_load_dwordx4 v2, s[8:11], s67 offen offset:3072 sc1 lds
    s_waitcnt lgkmcnt(6)
    ds_read_b64_tr_b16 a[60:61], v11 offset:14336
    ds_read_b64_tr_b16 a[62:63], v11 offset:14848
    v_mfma_f32_32x32x16_bf16 v[32:47], a[76:79], v[208:211], v[32:47]
    s_waitcnt vmcnt(17)
    v_max3_u32 v31, v224, v228, v232
    v_max3_u32 v31, v31, v236, v236
    v_cmp_eq_u32 vcc, -1, v31
    v_mfma_f32_32x32x16_bf16 v[32:47], a[80:83], v[212:215], v[32:47]
    s_cbranch_vccnz L_ag6_slow
L_ag6_ok:
    s_add_u32 m0, s57, 147456
    s_add_u32 s67, s56, 16384
    buffer_load_dwordx4 v2, s[8:11], s67 offen offset:0 sc1 lds
    v_mfma_f32_32x32x16_bf16 v[32:47], a[84:87], v[216:219], v[32:47]
    s_waitcnt vmcnt(5)
    v_max3_u32 v31, v120, v121, v122
    v_max3_u32 v31, v31, v123, v124
    v_max3_u32 v31, v31, v125, v126
    v_max3_u32 v31, v31, v127, v127
    v_cmp_eq_u32 vcc, -1, v31
    v_mfma_f32_32x32x16_bf16 v[32:47], a[88:91], v[220:223], v[32:47]
    s_cbranch_vccnz L_ss_slow
L_ss_ok:
    v_lshlrev_b32 v26, 16, v128
    v_lshlrev_b32 v27, 16, v128
    v_add_f32 v120, v120, v121
    v_add_f32 v122, v122, v123
    v_permlane32_swap_b32 v26, v27
    v_mfma_f32_32x32x16_bf16 v[32:47], a[92:95], v[224:227], v[32:47]
    v_max3_u32 v31, v240, v244, v248
    v_max3_u32 v31, v31, v252, v252
    v_cmp_eq_u32 vcc, -1, v31
    buffer_load_dwordx4 v2, s[8:11], s67 offen offset:1024 sc1 lds
    v_sub_f32 v6, v6, v26
    v_mfma_f32_32x32x16_bf16 v[32:47], a[96:99], v[228:231], v[32:47]
    s_cbranch_vccnz L_ag7_slow
L_ag7_ok:
    v_add_f32 v124, v124, v125
    v_add_f32 v126, v126, v127
    v_add_f32 v120, v120, v122
    v_add_f32 v124, v124, v126
    v_add_f32 v16, v120, v124
    v_mfma_f32_32x32x16_bf16 v[32:47], a[100:103], v[232:235], v[32:47]
    buffer_load_dwordx4 v2, s[8:11], s67 offen offset:2048 sc1 lds
    v_mov_b32 v17, v16
    v_mov_b32 v26, 0x3727c5ac
    s_nop 0
    v_permlane32_swap_b32 v16, v17
    v_add_f32 v16, v16, v17
    v_mfma_f32_32x32x16_bf16 v[32:47], a[104:107], v[236:239], v[32:47]
    v_fmamk_f32 v17, v16, 0x3b000000, v26
    v_rsq_f32 v16, v17
    ds_read_b64_tr_b16 a[64:65], v11 offset:16384
    ds_read_b64_tr_b16 a[66:67], v11 offset:16896
    v_mfma_f32_32x32x16_bf16 v[32:47], a[108:111], v[240:243], v[32:47]
    buffer_load_dwordx4 v2, s[8:11], s67 offen offset:3072 sc1 lds
    v_mul_f32 v16, 0xbfb8aa3b, v16
    ds_read_b64_tr_b16 a[68:69], v11 offset:18432
    ds_read_b64_tr_b16 a[70:71], v11 offset:18944
    v_mfma_f32_32x32x16_bf16 v[32:47], a[112:115], v[244:247], v[32:47]
    ds_read_b64_tr_b16 a[72:73], v11 offset:20480
    ds_read_b64_tr_b16 a[74:75], v11 offset:20992
    s_waitcnt lgkmcnt(6)
    ds_read_b64_tr_b16 a[76:77], v11 offset:22528
    ds_read_b64_tr_b16 a[78:79], v11 offset:23040
    v_mfma_f32_32x32x16_bf16 v[32:47], a[116:119], v[248:251], v[32:47]
    s_add_u32 m0, s57, 0
    s_add_u32 s67, s56, 32768
    buffer_load_dwordx4 v2, s[8:11], s67 offen offset:0 sc1 lds
    ds_read_b64_tr_b16 a[80:81], v11 offset:24576
    ds_read_b64_tr_b16 a[82:83], v11 offset:25088
    v_mfma_f32_32x32x16_bf16 v[32:47], a[120:123], v[252:255], v[32:47]
    ds_read_b64_tr_b16 a[84:85], v11 offset:26624
    ds_read_b64_tr_b16 a[86:87], v11 offset:27136
    ds_read_b64_tr_b16 a[88:89], v11 offset:28672
    ds_read_b64_tr_b16 a[90:91], v11 offset:29184
    v_mfma_f32_32x32x16_bf16 v[48:63], a[124:127], v[196:199], v[48:63]
    buffer_load_dwordx4 v2, s[8:11], s67 offen offset:1024 sc1 lds
    s_waitcnt lgkmcnt(6)
    ds_read_b64_tr_b16 a[92:93], v11 offset:30720
    ds_read_b64_tr_b16 a[94:95], v11 offset:31232
    v_mfma_f32_32x32x16_bf16 v[48:63], a[128:131], v[200:203], v[48:63]
    s_nop 1
    v_mul_f32 v40, v32, v40
    v_mul_f32 v41, v33, v41
    v_mul_f32 v32, v16, v32
    v_mul_f32 v33, v16, v33
    v_exp_f32 v32, v32
    v_mfma_f32_32x32x16_bf16 v[48:63], a[132:135], v[204:207], v[48:63]
    buffer_load_dwordx4 v2, s[8:11], s67 offen offset:2048 sc1 lds
    v_exp_f32 v33, v33
    v_fma_f32 v32, v32, v17, v17
    v_fma_f32 v33, v33, v17, v17
    v_mfma_f32_32x32x16_bf16 v[48:63], a[136:139], v[208:211], v[48:63]
    v_rcp_f32 v32, v32
    v_rcp_f32 v33, v33
    v_mul_f32 v40, v40, v32
    v_mul_f32 v41, v41, v33
    v_mfma_f32_32x32x16_bf16 v[48:63], a[140:143], v[212:215], v[48:63]
    buffer_load_dwordx4 v2, s[8:11], s67 offen offset:3072 sc1 lds
    v_cvt_pk_bf16_f32 v112, v40, v41
    v_mul_f32 v42, v34, v42
    v_mul_f32 v43, v35, v43
    v_mul_f32 v34, v16, v34
    v_mfma_f32_32x32x16_bf16 v[48:63], a[144:147], v[216:219], v[48:63]
    v_mul_f32 v35, v16, v35
    v_exp_f32 v34, v34
    v_exp_f32 v35, v35
    v_fma_f32 v34, v34, v17, v17
    v_mfma_f32_32x32x16_bf16 v[48:63], a[148:151], v[220:223], v[48:63]
    s_add_u32 m0, s57, 16384
    s_add_u32 s67, s56, 49152
    buffer_load_dwordx4 v2, s[8:11], s67 offen offset:0 sc1 lds
    v_fma_f32 v35, v35, v17, v17
    v_mul_f32 v44, v36, v44
    v_mfma_f32_32x32x16_bf16 v[48:63], a[152:155], v[224:227], v[48:63]
    v_rcp_f32 v34, v34
    v_rcp_f32 v35, v35
    v_mul_f32 v42, v42, v34
    v_mul_f32 v43, v43, v35
    v_mfma_f32_32x32x16_bf16 v[48:63], a[156:159], v[228:231], v[48:63]
    v_cvt_pk_bf16_f32 v113, v42, v43
    v_mul_f32 v45, v37, v45
    v_mul_f32 v36, v16, v36
    v_mul_f32 v37, v16, v37
    v_exp_f32 v36, v36
    v_mfma_f32_32x32x16_bf16 v[48:63], a[160:163], v[232:235], v[48:63]
    buffer_load_dwordx4 v2, s[8:11], s67 offen offset:1024 sc1 lds
    v_exp_f32 v37, v37
    v_fma_f32 v36, v36, v17, v17
    v_fma_f32 v37, v37, v17, v17
    v_mfma_f32_32x32x16_bf16 v[48:63], a[164:167], v[236:239], v[48:63]
    v_rcp_f32 v36, v36
    v_rcp_f32 v37, v37
    v_mul_f32 v44, v44, v36
    v_mul_f32 v45, v45, v37
    v_mfma_f32_32x32x16_bf16 v[48:63], a[168:171], v[240:243], v[48:63]
    buffer_load_dwordx4 v2, s[8:11], s67 offen offset:2048 sc1 lds
    v_cvt_pk_bf16_f32 v114, v44, v45
    v_mul_f32 v46, v38, v46
    v_mul_f32 v47, v39, v47
    v_mul_f32 v38, v16, v38
    v_mfma_f32_32x32x16_bf16 v[48:63], a[172:175], v[244:247], v[48:63]
    v_mul_f32 v39, v16, v39
    v_exp_f32 v38, v38
    v_exp_f32 v39, v39
    v_fma_f32 v38, v38, v17, v17
    v_mfma_f32_32x32x16_bf16 v[48:63], a[176:179], v[248:251], v[48:63]
    buffer_load_dwordx4 v2, s[8:11], s67 offen offset:3072 sc1 lds
    v_fma_f32 v39, v39, v17, v17
    v_rcp_f32 v38, v38
    v_mfma_f32_32x32x16_bf16 v[48:63], a[180:183], v[252:255], v[48:63]
    v_rcp_f32 v39, v39
    v_mul_f32 v46, v46, v38
    v_mul_f32 v47, v47, v39
    v_cvt_pk_bf16_f32 v115, v46, v47
    v_mfma_f32_32x32x16_bf16 v[64:79], a[184:187], v[196:199], v[64:79]
    s_add_u32 m0, s57, 32768
    s_add_u32 s67, s56, 65536
    buffer_load_dwordx4 v2, s[8:11], s67 offen offset:0 sc1 lds
    v_mfma_f32_32x32x16_bf16 v[64:79], a[188:191], v[200:203], v[64:79]
    buffer_store_dwordx4 v[112:115], v2, s[8:11], s48 offen offset:0 sc1
    s_nop 1
    v_mul_f32 v56, v48, v56
    v_mfma_f32_32x32x16_bf16 v[64:79], a[192:195], v[204:207], v[64:79]
    v_mul_f32 v57, v49, v57
    v_mul_f32 v48, v16, v48
    v_mul_f32 v49, v16, v49
    v_exp_f32 v48, v48
    v_mul_f32 v58, v50, v58
    v_mfma_f32_32x32x16_bf16 v[64:79], a[196:199], v[208:211], v[64:79]
    v_exp_f32 v49, v49
    v_fma_f32 v48, v48, v17, v17
    v_fma_f32 v49, v49, v17, v17
    v_rcp_f32 v48, v48
    v_mfma_f32_32x32x16_bf16 v[64:79], a[200:203], v[212:215], v[64:79]
    s_waitcnt vmcnt(10)
    s_waitcnt lgkmcnt(0)
    s_barrier
    buffer_load_dwordx4 v2, s[8:11], s67 offen offset:1024 sc1 lds
    v_mul_f32 v56, v56, v48
    v_mfma_f32_32x32x16_bf16 v[64:79], a[204:207], v[216:219], v[64:79]
    v_rcp_f32 v49, v49
    v_mul_f32 v59, v51, v59
    v_mul_f32 v57, v57, v49
    v_cvt_pk_bf16_f32 v116, v56, v57
    v_mul_f32 v50, v16, v50
    v_mfma_f32_32x32x16_bf16 v[64:79], a[0:3], v[220:223], v[64:79]
    buffer_load_dwordx4 v2, s[8:11], s67 offen offset:2048 sc1 lds
    v_mul_f32 v51, v16, v51
    v_exp_f32 v50, v50
    v_mul_f32 v60, v52, v60
    v_mfma_f32_32x32x16_bf16 v[64:79], a[4:7], v[224:227], v[64:79]
    v_exp_f32 v51, v51
    v_fma_f32 v50, v50, v17, v17
    v_fma_f32 v51, v51, v17, v17
    v_rcp_f32 v50, v50
    v_mfma_f32_32x32x16_bf16 v[64:79], a[8:11], v[228:231], v[64:79]
    buffer_load_dwordx4 v2, s[8:11], s67 offen offset:3072 sc1 lds
    v_rcp_f32 v51, v51
    v_mul_f32 v58, v58, v50
    v_mul_f32 v59, v59, v51
    v_mfma_f32_32x32x16_bf16 v[64:79], a[12:15], v[232:235], v[64:79]
    v_cvt_pk_bf16_f32 v117, v58, v59
    v_mul_f32 v61, v53, v61
    v_mul_f32 v52, v16, v52
    v_mul_f32 v53, v16, v53
    v_exp_f32 v52, v52
    v_mfma_f32_32x32x16_bf16 v[64:79], a[16:19], v[236:239], v[64:79]
    s_add_u32 m0, s57, 49152
    s_add_u32 s67, s56, 81920
    buffer_load_dwordx4 v2, s[8:11], s67 offen offset:0 sc1 lds
    v_exp_f32 v53, v53
    v_mfma_f32_32x32x16_bf16 v[64:79], a[20:23], v[240:243], v[64:79]
    v_fma_f32 v52, v52, v17, v17
    v_fma_f32 v53, v53, v17, v17
    v_rcp_f32 v52, v52
    v_rcp_f32 v53, v53
    v_mfma_f32_32x32x16_bf16 v[64:79], a[24:27], v[244:247], v[64:79]
    buffer_load_dwordx4 v2, s[8:11], s67 offen offset:1024 sc1 lds
    v_mul_f32 v60, v60, v52
    v_mul_f32 v61, v61, v53
    v_cvt_pk_bf16_f32 v118, v60, v61
    v_mul_f32 v62, v54, v62
    v_mfma_f32_32x32x16_bf16 v[64:79], a[28:31], v[248:251], v[64:79]
    v_mul_f32 v63, v55, v63
    v_mul_f32 v54, v16, v54
    v_mul_f32 v55, v16, v55
    v_exp_f32 v54, v54
    ds_read_b128 a[96:99], v12 offset:0
    v_mfma_f32_32x32x16_bf16 v[64:79], a[32:35], v[252:255], v[64:79]
    v_exp_f32 v55, v55
    v_fma_f32 v54, v54, v17, v17
    v_fma_f32 v55, v55, v17, v17
    v_rcp_f32 v54, v54
    v_mfma_f32_32x32x16_bf16 v[80:95], a[36:39], v[196:199], v[80:95]
    buffer_load_dwordx4 v2, s[8:11], s67 offen offset:2048 sc1 lds
    v_rcp_f32 v55, v55
    v_mul_f32 v62, v62, v54
    v_mul_f32 v63, v63, v55
    v_mfma_f32_32x32x16_bf16 v[80:95], a[40:43], v[200:203], v[80:95]
    v_cvt_pk_bf16_f32 v119, v62, v63
    buffer_store_dwordx4 v[116:119], v2, s[8:11], s48 offen offset:1024 sc1
    v_mfma_f32_32x32x16_bf16 v[80:95], a[44:47], v[204:207], v[80:95]
    v_mul_f32 v72, v64, v72
    v_mul_f32 v73, v65, v73
    v_mul_f32 v64, v16, v64
    v_mul_f32 v65, v16, v65
    v_exp_f32 v64, v64
    v_mfma_f32_32x32x16_bf16 v[80:95], a[48:51], v[208:211], v[80:95]
    v_exp_f32 v65, v65
    v_fma_f32 v64, v64, v17, v17
    v_fma_f32 v65, v65, v17, v17
    v_rcp_f32 v64, v64
L_pg3:
    s_cbranch_execz L_ret_w
    v_mfma_f32_32x32x16_bf16 v[80:95], a[52:55], v[212:215], v[80:95]
    buffer_load_dwordx4 v2, s[8:11], s67 offen offset:3072 sc1 lds
    v_rcp_f32 v65, v65
    v_mul_f32 v72, v72, v64
    v_mul_f32 v73, v73, v65
    v_mfma_f32_32x32x16_bf16 v[80:95], a[56:59], v[216:219], v[80:95]
    v_cvt_pk_bf16_f32 v120, v72, v73
    v_mul_f32 v74, v66, v74
    v_mul_f32 v75, v67, v75
    v_mul_f32 v66, v16, v66
    v_mul_f32 v67, v16, v67
    v_mul_f32 v76, v68, v76
    v_mfma_f32_32x32x16_bf16 v[80:95], a[60:63], v[220:223], v[80:95]
    s_lshl_b32 s66, s32, 10
    s_add_u32 m0, s66, 65536
    s_lshl4_add_u32 s67, s48, s40
    buffer_load_dwordx4 v13, s[20:23], s67 offen lds
    s_add_u32 m0, m0, 4096
    v_mfma_f32_32x32x16_bf16 v[80:95], a[64:67], v[224:227], v[80:95]
    ds_read_b128 a[100:103], v12 offset:1024
    v_exp_f32 v66, v66
    v_exp_f32 v67, v67
    v_fma_f32 v66, v66, v17, v17
    v_mfma_f32_32x32x16_bf16 v[80:95], a[68:71], v[228:231], v[80:95]
    ds_read_b128 a[104:107], v12 offset:2048
    s_lshl4_add_u32 s67, s48, s41
    buffer_load_dwordx4 v13, s[20:23], s67 offen lds
    s_add_u32 m0, m0, 4096
    v_fma_f32 v67, v67, v17, v17
    v_mfma_f32_32x32x16_bf16 v[80:95], a[72:75], v[232:235], v[80:95]
    ds_read_b128 a[108:111], v12 offset:3072
    v_rcp_f32 v66, v66
    v_rcp_f32 v67, v67
    v_mul_f32 v74, v74, v66
    v_mfma_f32_32x32x16_bf16 v[80:95], a[76:79], v[236:239], v[80:95]
    ds_read_b128 a[112:115], v12 offset:4096
    s_lshl4_add_u32 s67, s48, s42
    buffer_load_dwordx4 v13, s[20:23], s67 offen lds
    s_add_u32 m0, m0, 4096
    v_mul_f32 v75, v75, v67
    v_mfma_f32_32x32x16_bf16 v[80:95], a[80:83], v[240:243], v[80:95]
    ds_read_b128 a[116:119], v12 offset:5120
    v_cvt_pk_bf16_f32 v121, v74, v75
    v_mul_f32 v77, v69, v77
    v_mul_f32 v68, v16, v68
    v_mul_f32 v69, v16, v69
    v_mul_f32 v78, v70, v78
    v_mfma_f32_32x32x16_bf16 v[80:95], a[84:87], v[244:247], v[80:95]
    ds_read_b128 a[120:123], v12 offset:6144
    s_lshl4_add_u32 s67, s48, s43
    buffer_load_dwordx4 v13, s[20:23], s67 offen lds
    s_add_u32 m0, m0, 4096
    v_mul_f32 v79, v71, v79
    v_mfma_f32_32x32x16_bf16 v[80:95], a[88:91], v[248:251], v[80:95]
    ds_read_b128 a[124:127], v12 offset:7168
    v_exp_f32 v68, v68
    v_exp_f32 v69, v69
    v_fma_f32 v68, v68, v17, v17
    v_mfma_f32_32x32x16_bf16 v[80:95], a[92:95], v[252:255], v[80:95]
    ds_read_b128 a[128:131], v12 offset:8192
    s_lshl4_add_u32 s67, s49, s40
    buffer_load_dwordx4 v13, s[20:23], s67 offen lds
    s_add_u32 m0, m0, 4096
    s_waitcnt lgkmcnt(6)
    v_mfma_f32_32x32x16_bf16 v[96:111], a[96:99], v[128:131], 0
    ds_read_b128 a[132:135], v12 offset:9216
    v_fma_f32 v69, v69, v17, v17
    v_rcp_f32 v68, v68
    v_rcp_f32 v69, v69
    v_mfma_f32_32x32x16_bf16 v[96:111], a[100:103], v[132:135], v[96:111]
    ds_read_b128 a[136:139], v12 offset:10240
    s_lshl4_add_u32 s67, s50, s40
    buffer_load_dwordx4 v13, s[20:23], s67 offen lds
    s_add_u32 m0, m0, 4096
    v_mul_f32 v76, v76, v68
    v_mfma_f32_32x32x16_bf16 v[96:111], a[104:107], v[136:139], v[96:111]
    ds_read_b128 a[140:143], v12 offset:11264
    v_mul_f32 v77, v77, v69
    v_cvt_pk_bf16_f32 v122, v76, v77
    v_mul_f32 v70, v16, v70
    v_mul_f32 v71, v16, v71
    s_waitcnt lgkmcnt(6)
    v_mfma_f32_32x32x16_bf16 v[96:111], a[108:111], v[140:143], v[96:111]
    ds_read_b128 a[144:147], v12 offset:12288
    s_lshl4_add_u32 s67, s51, s40
    buffer_load_dwordx4 v13, s[20:23], s67 offen lds
    s_add_u32 m0, m0, 4096
    ds_read_b128 a[148:151], v12 offset:13312
    v_mfma_f32_32x32x16_bf16 v[96:111], a[112:115], v[144:147], v[96:111]
    v_exp_f32 v70, v70
    v_exp_f32 v71, v71
    v_fma_f32 v70, v70, v17, v17
    v_fma_f32 v71, v71, v17, v17
    v_mfma_f32_32x32x16_bf16 v[96:111], a[116:119], v[148:151], v[96:111]
    ds_read_b128 a[152:155], v12 offset:14336
    s_lshl4_add_u32 s67, s49, s41
    buffer_load_dwordx4 v13, s[20:23], s67 offen lds
    s_add_u32 m0, m0, 4096
    s_waitcnt lgkmcnt(6)
    v_mfma_f32_32x32x16_bf16 v[96:111], a[120:123], v[152:155], v[96:111]
    ds_read_b128 a[156:159], v12 offset:15360
    v_rcp_f32 v70, v70
    v_rcp_f32 v71, v71
    v_mul_f32 v78, v78, v70
    v_mfma_f32_32x32x16_bf16 v[96:111], a[124:127], v[156:159], v[96:111]
    ds_read_b128 a[160:163], v12 offset:16384
    s_lshl4_add_u32 s67, s50, s41
    buffer_load_dwordx4 v13, s[20:23], s67 offen lds
    s_add_u32 m0, m0, 4096
    v_mul_f32 v79, v79, v71
    v_mfma_f32_32x32x16_bf16 v[96:111], a[128:131], v[160:163], v[96:111]
    ds_read_b128 a[164:167], v12 offset:17408
    v_cvt_pk_bf16_f32 v123, v78, v79
    ds_read_b128 a[168:171], v12 offset:18432
    s_waitcnt lgkmcnt(7)
    v_mfma_f32_32x32x16_bf16 v[96:111], a[132:135], v[164:167], v[96:111]
    s_waitcnt vmcnt(10)
    buffer_store_dword v30, v15, s[8:11], s59 offen offset:16 sc1
    s_lshl4_add_u32 s67, s51, s41
    buffer_load_dwordx4 v13, s[20:23], s67 offen lds
    s_add_u32 m0, m0, 4096
    v_mfma_f32_32x32x16_bf16 v[96:111], a[136:139], v[168:171], v[96:111]
    ds_read_b128 a[172:175], v12 offset:19456
    buffer_store_dwordx4 v[120:123], v2, s[8:11], s48 offen offset:2048 sc1
    v_mfma_f32_32x32x16_bf16 v[96:111], a[140:143], v[172:175], v[96:111]
    ds_read_b128 a[176:179], v12 offset:20480
    v_mul_f32 v88, v80, v88
    v_mul_f32 v89, v81, v89
    v_mul_f32 v80, v16, v80
    v_mul_f32 v81, v16, v81
    s_waitcnt lgkmcnt(6)
    v_mfma_f32_32x32x16_bf16 v[96:111], a[144:147], v[176:179], v[96:111]
    ds_read_b128 a[180:183], v12 offset:21504
    v_exp_f32 v80, v80
    v_exp_f32 v81, v81
    v_fma_f32 v80, v80, v17, v17
    v_mfma_f32_32x32x16_bf16 v[96:111], a[148:151], v[180:183], v[96:111]
    ds_read_b128 a[184:187], v12 offset:22528
    s_lshl4_add_u32 s67, s49, s42
    buffer_load_dwordx4 v13, s[20:23], s67 offen lds
    s_add_u32 m0, m0, 4096
    v_fma_f32 v81, v81, v17, v17
    v_mfma_f32_32x32x16_bf16 v[96:111], a[152:155], v[184:187], v[96:111]
    ds_read_b128 a[188:191], v12 offset:23552
    v_rcp_f32 v80, v80
    v_rcp_f32 v81, v81
    s_waitcnt lgkmcnt(6)
    v_mfma_f32_32x32x16_bf16 v[96:111], a[156:159], v[188:191], v[96:111]
    ds_read_b128 a[192:195], v12 offset:24576
    s_lshl4_add_u32 s67, s50, s42
    buffer_load_dwordx4 v13, s[20:23], s67 offen lds
    s_add_u32 m0, m0, 4096
    v_mul_f32 v88, v88, v80
    v_mfma_f32_32x32x16_bf16 v[96:111], a[160:163], v[192:195], v[96:111]
    ds_read_b128 a[196:199], v12 offset:25600
    v_mul_f32 v89, v89, v81
    v_cvt_pk_bf16_f32 v124, v88, v89
    v_mul_f32 v90, v82, v90
    v_mul_f32 v91, v83, v91
    v_mul_f32 v82, v16, v82
    v_mfma_f32_32x32x16_bf16 v[96:111], a[164:167], v[196:199], v[96:111]
    ds_read_b128 a[200:203], v12 offset:26624
    s_lshl4_add_u32 s67, s51, s42
    buffer_load_dwordx4 v13, s[20:23], s67 offen lds
    s_add_u32 m0, m0, 4096
    s_waitcnt lgkmcnt(6)
    v_mfma_f32_32x32x16_bf16 v[96:111], a[168:171], v[200:203], v[96:111]
    s_waitcnt vmcnt(15)
    s_barrier
    ds_read_b128 a[204:207], v12 offset:27648
    v_mul_f32 v83, v16, v83
    v_exp_f32 v82, v82
    v_mfma_f32_32x32x16_bf16 v[96:111], a[172:175], v[204:207], v[96:111]
    ds_read_b128 a[0:3], v12 offset:28672
    v_exp_f32 v83, v83
    v_fma_f32 v82, v82, v17, v17
    v_fma_f32 v83, v83, v17, v17
    v_mul_f32 v92, v84, v92
    v_mfma_f32_32x32x16_bf16 v[96:111], a[176:179], v[208:211], v[96:111]
    ds_read_b128 a[4:7], v12 offset:29696
    s_lshl4_add_u32 s67, s49, s43
    buffer_load_dwordx4 v13, s[20:23], s67 offen lds
    s_add_u32 m0, m0, 4096
    s_waitcnt lgkmcnt(6)
    v_mfma_f32_32x32x16_bf16 v[96:111], a[180:183], v[212:215], v[96:111]
    ds_read_b128 a[8:11], v12 offset:30720
    v_rcp_f32 v82, v82
    v_rcp_f32 v83, v83
    v_mul_f32 v90, v90, v82
    v_mfma_f32_32x32x16_bf16 v[96:111], a[184:187], v[216:219], v[96:111]
    ds_read_b128 a[12:15], v12 offset:31744
    s_lshl4_add_u32 s67, s50, s43
    buffer_load_dwordx4 v13, s[20:23], s67 offen lds
    s_add_u32 m0, m0, 4096
    v_mul_f32 v91, v91, v83
    v_mfma_f32_32x32x16_bf16 v[96:111], a[188:191], v[220:223], v[96:111]
    v_cvt_pk_bf16_f32 v125, v90, v91
    v_mul_f32 v93, v85, v93
    v_mul_f32 v84, v16, v84
    v_mul_f32 v85, v16, v85
    v_mul_f32 v94, v86, v94
    s_waitcnt lgkmcnt(5)
    v_mfma_f32_32x32x16_bf16 v[96:111], a[192:195], v[224:227], v[96:111]
    s_lshl4_add_u32 s67, s51, s43
    buffer_load_dwordx4 v13, s[20:23], s67 offen lds
    s_add_u32 m0, m0, 4096
    v_exp_f32 v84, v84
    v_mfma_f32_32x32x16_bf16 v[96:111], a[196:199], v[228:231], v[96:111]
    ds_read_b128 a[16:19], v2 offset:0
    v_exp_f32 v85, v85
    v_fma_f32 v84, v84, v17, v17
    v_fma_f32 v85, v85, v17, v17
    v_mul_f32 v95, v87, v95
    v_mfma_f32_32x32x16_bf16 v[96:111], a[200:203], v[232:235], v[96:111]
    ds_read_b128 a[20:23], v2 offset:1024
    v_rcp_f32 v84, v84
    v_rcp_f32 v85, v85
    s_waitcnt lgkmcnt(4)
    v_mfma_f32_32x32x16_bf16 v[96:111], a[204:207], v[236:239], v[96:111]
    ds_read_b128 a[24:27], v2 offset:2048
    v_mul_f32 v92, v92, v84
    v_mul_f32 v93, v93, v85
    v_cvt_pk_bf16_f32 v126, v92, v93
    v_mul_f32 v86, v16, v86
    v_mul_f32 v87, v16, v87
    v_mfma_f32_32x32x16_bf16 v[96:111], a[0:3], v[240:243], v[96:111]
    s_waitcnt lgkmcnt(3)
    s_barrier
    ds_read_b128 a[28:31], v2 offset:3072
    v_exp_f32 v86, v86
    v_mfma_f32_32x32x16_bf16 v[96:111], a[4:7], v[244:247], v[96:111]
    ds_read_b128 a[32:35], v2 offset:4096
    s_lshl4_add_u32 s67, s52, s40
    buffer_load_dwordx4 v13, s[20:23], s67 offen lds
    s_add_u32 m0, m0, 4096
    v_fma_f32 v86, v86, v17, v17
    v_mfma_f32_32x32x16_bf16 v[96:111], a[8:11], v[248:251], v[96:111]
    ds_read_b128 a[36:39], v2 offset:5120
    s_lshl4_add_u32 s67, s53, s40
    buffer_load_dwordx4 v13, s[20:23], s67 offen lds
    s_add_u32 m0, m0, 4096
    ds_read_b128 a[40:43], v2 offset:6144
    v_mfma_f32_32x32x16_bf16 v[96:111], a[12:15], v[252:255], v[96:111]
    s_lshl4_add_u32 s67, s54, s40
    buffer_load_dwordx4 v13, s[20:23], s67 offen lds
    s_add_u32 m0, m0, 4096
    ds_read_b128 a[44:47], v2 offset:7168
    s_waitcnt lgkmcnt(5)
    v_mfma_f32_32x32x16_bf16 v[32:47], a[16:19], v[128:131], 0
    s_lshl4_add_u32 s67, s55, s40
    buffer_load_dwordx4 v13, s[20:23], s67 offen lds
    s_add_u32 m0, m0, 4096
    v_exp_f32 v87, v87
    v_mfma_f32_32x32x16_bf16 v[32:47], a[20:23], v[132:135], v[32:47]
    ds_read_b128 a[48:51], v2 offset:8192
    v_fma_f32 v87, v87, v17, v17
    v_rcp_f32 v86, v86
    v_rcp_f32 v87, v87
    v_mfma_f32_32x32x16_bf16 v[32:47], a[24:27], v[136:139], v[32:47]
    ds_read_b128 a[52:55], v2 offset:9216
    s_lshl4_add_u32 s67, s52, s41
    buffer_load_dwordx4 v13, s[20:23], s67 offen lds
    s_add_u32 m0, m0, 4096
    s_waitcnt lgkmcnt(4)
    v_mfma_f32_32x32x16_bf16 v[32:47], a[28:31], v[140:143], v[32:47]
    ds_read_b128 a[56:59], v2 offset:10240
    v_mul_f32 v94, v94, v86
    v_mul_f32 v95, v95, v87
    v_cvt_pk_bf16_f32 v127, v94, v95
    ds_read_b128 a[60:63], v2 offset:11264
    v_mfma_f32_32x32x16_bf16 v[32:47], a[32:35], v[144:147], v[32:47]
    s_lshl4_add_u32 s67, s53, s41
    buffer_load_dwordx4 v13, s[20:23], s67 offen lds
    s_add_u32 m0, m0, 4096
    ds_read_b128 a[64:67], v2 offset:12288
    ds_read_b128 a[68:71], v2 offset:13312
    v_mfma_f32_32x32x16_bf16 v[32:47], a[36:39], v[148:151], v[32:47]
    buffer_store_dwordx4 v[124:127], v2, s[8:11], s48 offen offset:3072 sc1
    s_waitcnt lgkmcnt(5)
    v_mfma_f32_32x32x16_bf16 v[32:47], a[40:43], v[152:155], v[32:47]
    v_mul_f32 v104, v96, v104
    v_mul_f32 v105, v97, v105
    v_mul_f32 v96, v16, v96
    v_mul_f32 v97, v16, v97
    v_exp_f32 v96, v96
    v_mfma_f32_32x32x16_bf16 v[32:47], a[44:47], v[156:159], v[32:47]
    ds_read_b128 a[72:75], v2 offset:14336
    v_exp_f32 v97, v97
    v_fma_f32 v96, v96, v17, v17
    v_fma_f32 v97, v97, v17, v17
    v_mul_f32 v106, v98, v106
    v_mfma_f32_32x32x16_bf16 v[32:47], a[48:51], v[160:163], v[32:47]
    ds_read_b128 a[76:79], v2 offset:15360
    s_lshl4_add_u32 s67, s54, s41
    buffer_load_dwordx4 v13, s[20:23], s67 offen lds
    s_add_u32 m0, m0, 4096
    s_waitcnt lgkmcnt(4)
    v_mfma_f32_32x32x16_bf16 v[32:47], a[52:55], v[164:167], v[32:47]
    ds_read_b128 a[80:83], v2 offset:16384
    v_rcp_f32 v96, v96
    v_rcp_f32 v97, v97
    v_mul_f32 v104, v104, v96
    v_mfma_f32_32x32x16_bf16 v[32:47], a[56:59], v[168:171], v[32:47]
    ds_read_b128 a[84:87], v2 offset:17408
    s_lshl4_add_u32 s67, s55, s41
    buffer_load_dwordx4 v13, s[20:23], s67 offen lds
    s_add_u32 m0, m0, 4096
    v_mul_f32 v105, v105, v97
    v_mfma_f32_32x32x16_bf16 v[32:47], a[60:63], v[172:175], v[32:47]
    ds_read_b128 a[88:91], v2 offset:18432
    v_cvt_pk_bf16_f32 v22, v104, v105
    v_mul_f32 v107, v99, v107
    v_mul_f32 v98, v16, v98
    v_mul_f32 v99, v16, v99
    s_waitcnt lgkmcnt(4)
    v_mfma_f32_32x32x16_bf16 v[32:47], a[64:67], v[176:179], v[32:47]
    ds_read_b128 a[92:95], v2 offset:19456
    v_exp_f32 v98, v98
    v_exp_f32 v99, v99
    v_fma_f32 v98, v98, v17, v17
    v_mfma_f32_32x32x16_bf16 v[32:47], a[68:71], v[180:183], v[32:47]
    buffer_load_dword v28, v19, s[8:11], s58 offen offset:16 sc1
    ds_read_b128 a[96:99], v2 offset:20480
    v_fma_f32 v99, v99, v17, v17
    v_rcp_f32 v98, v98
    v_mfma_f32_32x32x16_bf16 v[32:47], a[72:75], v[184:187], v[32:47]
    ds_read_b128 a[100:103], v2 offset:21504
    v_rcp_f32 v99, v99
    v_mul_f32 v106, v106, v98
    v_mul_f32 v107, v107, v99
    s_waitcnt lgkmcnt(4)
    v_mfma_f32_32x32x16_bf16 v[32:47], a[76:79], v[188:191], v[32:47]
    ds_read_b128 a[104:107], v2 offset:22528
    v_cvt_pk_bf16_f32 v23, v106, v107
    v_mul_f32 v108, v100, v108
    v_mul_f32 v109, v101, v109
    v_mul_f32 v100, v16, v100
    v_mul_f32 v101, v16, v101
    v_mfma_f32_32x32x16_bf16 v[32:47], a[80:83], v[192:195], v[32:47]
    ds_read_b128 a[108:111], v2 offset:23552
    v_exp_f32 v100, v100
    v_exp_f32 v101, v101
    v_fma_f32 v100, v100, v17, v17
    v_mfma_f32_32x32x16_bf16 v[32:47], a[84:87], v[196:199], v[32:47]
    ds_read_b128 a[112:115], v2 offset:24576
    v_fma_f32 v101, v101, v17, v17
    v_rcp_f32 v100, v100
    v_mul_f32 v110, v102, v110
    s_waitcnt lgkmcnt(4)
    v_mfma_f32_32x32x16_bf16 v[32:47], a[88:91], v[200:203], v[32:47]
    ds_read_b128 a[116:119], v2 offset:25600
    v_rcp_f32 v101, v101
    v_mul_f32 v108, v108, v100
    v_mul_f32 v109, v109, v101
    v_cvt_pk_bf16_f32 v24, v108, v109
    v_mfma_f32_32x32x16_bf16 v[32:47], a[92:95], v[204:207], v[32:47]
    ds_read_b128 a[120:123], v2 offset:26624
    v_mul_f32 v111, v103, v111
    v_mul_f32 v102, v16, v102
    v_mul_f32 v103, v16, v103
    v_exp_f32 v102, v102
    v_mfma_f32_32x32x16_bf16 v[32:47], a[96:99], v[208:211], v[32:47]
    ds_read_b128 a[124:127], v2 offset:27648
    v_exp_f32 v103, v103
    v_fma_f32 v102, v102, v17, v17
    v_fma_f32 v103, v103, v17, v17
    s_waitcnt lgkmcnt(4)
    v_mfma_f32_32x32x16_bf16 v[32:47], a[100:103], v[212:215], v[32:47]
    ds_read_b128 a[128:131], v2 offset:28672
    v_rcp_f32 v102, v102
    v_rcp_f32 v103, v103
    v_mul_f32 v110, v110, v102
    v_mfma_f32_32x32x16_bf16 v[32:47], a[104:107], v[216:219], v[32:47]
    ds_read_b128 a[132:135], v2 offset:29696
    v_mul_f32 v111, v111, v103
    v_cvt_pk_bf16_f32 v25, v110, v111
    ds_read_b128 a[136:139], v2 offset:30720
    v_mfma_f32_32x32x16_bf16 v[32:47], a[108:111], v[220:223], v[32:47]
    buffer_store_dwordx4 v[22:25], v2, s[8:11], s52 offen offset:0 sc1
    s_waitcnt lgkmcnt(4)
    v_mfma_f32_32x32x16_bf16 v[32:47], a[112:115], v[224:227], v[32:47]
    ds_read_b128 a[140:143], v2 offset:31744
    v_bfe_u32 v26, v1, 2, 2
    v_lshlrev_b32 v8, 6, v26
    v_lshl_add_u32 v26, v4, 3, v26
    v_lshl_add_u32 v8, v26, 8, v8
    v_mfma_f32_32x32x16_bf16 v[32:47], a[116:119], v[228:231], v[32:47]
    v_and_b32 v27, 24, v14
    v_and_b32 v26, 16, v1
    v_lshl_add_u32 v27, v26, 1, v27
    v_add_u32 v8, v8, v27
    s_lshr_b32 s39, s36, 2
    s_lshl_b32 s39, s39, 6
    v_mfma_f32_32x32x16_bf16 v[32:47], a[120:123], v[232:235], v[32:47]
    ds_read_b128 a[144:147], v2 offset:32768
    v_xor_b32 v8, s39, v8
    v_add_u32 v8, 65536, v8
    v_xor_b32 v9, 64, v8
    v_xor_b32 v10, 128, v8
    s_waitcnt lgkmcnt(3)
    v_mfma_f32_32x32x16_bf16 v[32:47], a[124:127], v[236:239], v[32:47]
    ds_read_b128 a[148:151], v2 offset:33792
    v_xor_b32 v11, 192, v8
    v_and_b32 v21, 0x10001, v30
    s_mov_b32 s29, 0xfffefffe
    ds_read_b128 a[152:155], v2 offset:34816
    v_mfma_f32_32x32x16_bf16 v[32:47], a[128:131], v[240:243], v[32:47]
    ds_read_b128 a[156:159], v2 offset:35840
    ds_read_b128 a[160:163], v2 offset:36864
    v_mfma_f32_32x32x16_bf16 v[32:47], a[132:135], v[244:247], v[32:47]
    ds_read_b128 a[164:167], v2 offset:37888
    s_waitcnt lgkmcnt(5)
    v_mfma_f32_32x32x16_bf16 v[32:47], a[136:139], v[248:251], v[32:47]
    s_waitcnt vmcnt(11)
    s_barrier
    ds_read_b128 a[168:171], v2 offset:38912
    ds_read_b128 a[172:175], v2 offset:39936
    v_mfma_f32_32x32x16_bf16 v[32:47], a[140:143], v[252:255], v[32:47]
    s_lshl_b32 s66, s32, 10
    s_add_u32 m0, s66, 0
    s_lshl4_add_u32 s67, s52, s97
    buffer_load_dwordx4 v20, s[20:23], s67 offen lds
    s_add_u32 m0, m0, 4096
    v_mfma_f32_32x32x16_bf16 v[48:63], a[144:147], v[128:131], 0
    s_lshl4_add_u32 s67, s53, s97
    buffer_load_dwordx4 v20, s[20:23], s67 offen lds
    s_add_u32 m0, m0, 4096
    ds_read_b128 a[176:179], v2 offset:40960
    s_waitcnt lgkmcnt(5)
    v_mfma_f32_32x32x16_bf16 v[48:63], a[148:151], v[132:135], v[48:63]
    s_lshl4_add_u32 s67, s54, s97
    buffer_load_dwordx4 v20, s[20:23], s67 offen lds
    s_add_u32 m0, m0, 4096
    v_mul_f32 v40, v32, v40
    v_mul_f32 v41, v33, v41
    v_mfma_f32_32x32x16_bf16 v[48:63], a[152:155], v[136:139], v[48:63]
    s_lshl4_add_u32 s67, s55, s97
    buffer_load_dwordx4 v20, s[20:23], s67 offen lds
    s_add_u32 m0, m0, 4096
    v_mul_f32 v32, v16, v32
    v_mul_f32 v33, v16, v33
    v_mfma_f32_32x32x16_bf16 v[48:63], a[156:159], v[140:143], v[48:63]
    ds_read_b128 a[180:183], v2 offset:41984
    v_exp_f32 v32, v32
    v_exp_f32 v33, v33
    s_waitcnt lgkmcnt(3)
    v_mfma_f32_32x32x16_bf16 v[48:63], a[160:163], v[144:147], v[48:63]
    ds_read_b128 a[184:187], v2 offset:43008
    v_fma_f32 v32, v32, v17, v17
    v_fma_f32 v33, v33, v17, v17
    v_rcp_f32 v32, v32
    v_mul_f32 v42, v34, v42
    v_mfma_f32_32x32x16_bf16 v[48:63], a[164:167], v[148:151], v[48:63]
    ds_read_b128 a[188:191], v2 offset:44032
    v_rcp_f32 v33, v33
    v_mul_f32 v40, v40, v32
    v_mul_f32 v41, v41, v33
    v_cvt_pk_bf16_f32 v32, v40, v41
    v_mfma_f32_32x32x16_bf16 v[48:63], a[168:171], v[152:155], v[48:63]
    ds_read_b128 a[192:195], v2 offset:45056
    v_mul_f32 v43, v35, v43
    v_mul_f32 v34, v16, v34
    v_mul_f32 v35, v16, v35
    v_mul_f32 v44, v36, v44
    s_waitcnt lgkmcnt(3)
    v_mfma_f32_32x32x16_bf16 v[48:63], a[172:175], v[156:159], v[48:63]
    s_waitcnt vmcnt(5)
    v_cmp_ne_u32 vcc, v30, v28
    ds_read_b128 a[196:199], v2 offset:46080
    v_exp_f32 v34, v34
    v_mul_f32 v45, v37, v45
    v_mfma_f32_32x32x16_bf16 v[48:63], a[176:179], v[160:163], v[48:63]
    s_cbranch_vccnz L_f30_slow
L_f30_ok:
    ds_read_b128 a[200:203], v2 offset:47104
    buffer_load_dwordx4 a[208:211], v2, s[8:11], s49 offen offset:0 sc1
    v_exp_f32 v35, v35
    v_mfma_f32_32x32x16_bf16 v[48:63], a[180:183], v[164:167], v[48:63]
    ds_read_b128 a[204:207], v2 offset:48128
    buffer_load_dwordx4 a[212:215], v2, s[8:11], s50 offen offset:0 sc1
    v_fma_f32 v34, v34, v17, v17
    v_fma_f32 v35, v35, v17, v17
    s_waitcnt lgkmcnt(3)
    v_mfma_f32_32x32x16_bf16 v[48:63], a[184:187], v[168:171], v[48:63]
    ds_read_b128 a[0:3], v2 offset:49152
    buffer_load_dwordx4 a[216:219], v2, s[8:11], s51 offen offset:0 sc1
    v_rcp_f32 v34, v34
    v_mul_f32 v36, v16, v36
    v_mfma_f32_32x32x16_bf16 v[48:63], a[188:191], v[172:175], v[48:63]
    ds_read_b128 a[4:7], v2 offset:50176
    buffer_load_dwordx4 a[220:223], v2, s[8:11], s49 offen offset:1024 sc1
    v_rcp_f32 v35, v35
    v_mul_f32 v42, v42, v34
    v_mfma_f32_32x32x16_bf16 v[48:63], a[192:195], v[176:179], v[48:63]
    ds_read_b128 a[8:11], v2 offset:51200
    v_mul_f32 v43, v43, v35
    v_cvt_pk_bf16_f32 v33, v42, v43
    v_mul_f32 v37, v16, v37
    v_mul_f32 v46, v38, v46
    s_waitcnt lgkmcnt(3)
    v_mfma_f32_32x32x16_bf16 v[48:63], a[196:199], v[180:183], v[48:63]
    ds_read_b128 a[12:15], v2 offset:52224
    buffer_load_dwordx4 a[224:227], v2, s[8:11], s50 offen offset:1024 sc1
    v_exp_f32 v36, v36
    v_mul_f32 v47, v39, v47
    v_mfma_f32_32x32x16_bf16 v[48:63], a[200:203], v[184:187], v[48:63]
    ds_read_b128 a[16:19], v2 offset:53248
    v_exp_f32 v37, v37
    v_fma_f32 v36, v36, v17, v17
    v_fma_f32 v37, v37, v17, v17
    v_mul_f32 v38, v16, v38
    v_mfma_f32_32x32x16_bf16 v[48:63], a[204:207], v[188:191], v[48:63]
    ds_read_b128 a[20:23], v2 offset:54272
    buffer_load_dwordx4 a[228:231], v2, s[8:11], s51 offen offset:1024 sc1
    v_rcp_f32 v36, v36
    s_waitcnt lgkmcnt(3)
    v_mfma_f32_32x32x16_bf16 v[48:63], a[0:3], v[192:195], v[48:63]
    ds_read_b128 a[24:27], v2 offset:55296
    v_rcp_f32 v37, v37
    v_mul_f32 v44, v44, v36
    v_mul_f32 v45, v45, v37
    v_cvt_pk_bf16_f32 v34, v44, v45
    v_mfma_f32_32x32x16_bf16 v[48:63], a[4:7], v[196:199], v[48:63]
    ds_read_b128 a[28:31], v2 offset:56320
    buffer_load_dwordx4 v[128:131], v2, s[8:11], s49 offen offset:2048 sc1
    v_mul_f32 v39, v16, v39
    v_exp_f32 v38, v38
    v_mfma_f32_32x32x16_bf16 v[48:63], a[8:11], v[200:203], v[48:63]
    ds_read_b128 a[32:35], v2 offset:57344
    v_exp_f32 v39, v39
    v_fma_f32 v38, v38, v17, v17
    v_fma_f32 v39, v39, v17, v17
    s_waitcnt lgkmcnt(3)
    v_mfma_f32_32x32x16_bf16 v[48:63], a[12:15], v[204:207], v[48:63]
    ds_read_b128 a[36:39], v2 offset:58368
    buffer_load_dwordx4 v[132:135], v2, s[8:11], s50 offen offset:2048 sc1
    v_rcp_f32 v38, v38
    ds_read_b128 a[40:43], v2 offset:59392
    v_mfma_f32_32x32x16_bf16 v[48:63], a[16:19], v[208:211], v[48:63]
    v_rcp_f32 v39, v39
    v_mul_f32 v46, v46, v38
    v_mul_f32 v47, v47, v39
    v_cvt_pk_bf16_f32 v35, v46, v47
    v_mfma_f32_32x32x16_bf16 v[48:63], a[20:23], v[212:215], v[48:63]
    ds_read_b128 a[44:47], v2 offset:60416
    buffer_load_dwordx4 v[136:139], v2, s[8:11], s51 offen offset:2048 sc1
    s_waitcnt lgkmcnt(3)
    v_mfma_f32_32x32x16_bf16 v[48:63], a[24:27], v[216:219], v[48:63]
    ds_read_b128 a[48:51], v2 offset:61440
    buffer_store_dwordx4 v[32:35], v2, s[8:11], s52 offen offset:1024 sc1
    v_mfma_f32_32x32x16_bf16 v[48:63], a[28:31], v[220:223], v[48:63]
    ds_read_b128 a[52:55], v2 offset:62464
    ds_read_b128 a[56:59], v2 offset:63488
    v_mfma_f32_32x32x16_bf16 v[48:63], a[32:35], v[224:227], v[48:63]
    ds_read_b128 a[60:63], v2 offset:64512
    s_waitcnt lgkmcnt(4)
    v_mfma_f32_32x32x16_bf16 v[48:63], a[36:39], v[228:231], v[48:63]
    buffer_load_dwordx4 v[140:143], v2, s[8:11], s49 offen offset:3072 sc1
    ds_read_b64_tr_b16 a[64:65], v9 offset:0
    ds_read_b64_tr_b16 a[66:67], v9 offset:1024
    ds_read_b64_tr_b16 a[68:69], v10 offset:0
    ds_read_b64_tr_b16 a[70:71], v10 offset:1024
    v_mfma_f32_32x32x16_bf16 v[48:63], a[40:43], v[232:235], v[48:63]
    ds_read_b64_tr_b16 a[72:73], v11 offset:0
    ds_read_b64_tr_b16 a[74:75], v11 offset:1024
    ds_read_b64_tr_b16 a[76:77], v9 offset:4096
    ds_read_b64_tr_b16 a[78:79], v9 offset:5120
    v_mfma_f32_32x32x16_bf16 v[48:63], a[44:47], v[236:239], v[48:63]
    buffer_load_dwordx4 v[144:147], v2, s[8:11], s50 offen offset:3072 sc1
    ds_read_b64_tr_b16 a[80:81], v10 offset:4096
    ds_read_b64_tr_b16 a[82:83], v10 offset:5120
    s_waitcnt lgkmcnt(11)
    v_mfma_f32_32x32x16_bf16 v[48:63], a[48:51], v[240:243], v[48:63]
    ds_read_b64_tr_b16 a[84:85], v11 offset:4096
    ds_read_b64_tr_b16 a[86:87], v11 offset:5120
    s_waitcnt lgkmcnt(6)
    ds_read_b64_tr_b16 a[88:89], v9 offset:8192
    ds_read_b64_tr_b16 a[90:91], v9 offset:9216
    v_mfma_f32_32x32x16_bf16 v[48:63], a[52:55], v[244:247], v[48:63]
    buffer_load_dwordx4 v[148:151], v2, s[8:11], s51 offen offset:3072 sc1
    ds_read_b64_tr_b16 a[92:93], v10 offset:8192
    ds_read_b64_tr_b16 a[94:95], v10 offset:9216
    ds_read_b64_tr_b16 a[96:97], v11 offset:8192
    ds_read_b64_tr_b16 a[98:99], v11 offset:9216
    v_mfma_f32_32x32x16_bf16 v[48:63], a[56:59], v[248:251], v[48:63]
    ds_read_b64_tr_b16 a[100:101], v9 offset:12288
    ds_read_b64_tr_b16 a[102:103], v9 offset:13312
    v_mfma_f32_32x32x16_bf16 v[48:63], a[60:63], v[252:255], v[48:63]
    s_waitcnt lgkmcnt(6)
    ds_read_b64_tr_b16 a[104:105], v10 offset:12288
    ds_read_b64_tr_b16 a[106:107], v10 offset:13312
    ds_read_b64_tr_b16 a[108:109], v11 offset:12288
    ds_read_b64_tr_b16 a[110:111], v11 offset:13312
    v_mfma_f32_32x32x16_bf16 v[64:79], a[64:67], v[112:115], 0
    ds_read_b64_tr_b16 a[112:113], v9 offset:16384
    ds_read_b64_tr_b16 a[114:115], v9 offset:17408
    ds_read_b64_tr_b16 a[116:117], v10 offset:16384
    ds_read_b64_tr_b16 a[118:119], v10 offset:17408
    v_mfma_f32_32x32x16_bf16 v[80:95], a[68:71], v[112:115], 0
    s_nop 0
    v_mul_f32 v56, v48, v56
    v_mul_f32 v57, v49, v57
    v_mul_f32 v48, v16, v48
    v_mul_f32 v49, v16, v49
    v_exp_f32 v48, v48
    v_exp_f32 v49, v49
    v_mfma_f32_32x32x16_bf16 v[96:111], a[72:75], v[112:115], 0
    v_fma_f32 v48, v48, v17, v17
    v_fma_f32 v49, v49, v17, v17
    v_rcp_f32 v48, v48
    v_rcp_f32 v49, v49
    v_mul_f32 v56, v56, v48
    v_mul_f32 v57, v57, v49
    v_mfma_f32_32x32x16_bf16 v[64:79], a[76:79], v[116:119], v[64:79]
    v_cvt_pk_bf16_f32 v48, v56, v57
    v_mul_f32 v58, v50, v58
    v_mul_f32 v59, v51, v59
    v_mul_f32 v50, v16, v50
    v_mul_f32 v51, v16, v51
    v_exp_f32 v50, v50
    v_mul_f32 v60, v52, v60
    v_mfma_f32_32x32x16_bf16 v[80:95], a[80:83], v[116:119], v[80:95]
    v_exp_f32 v51, v51
    v_fma_f32 v50, v50, v17, v17
    v_fma_f32 v51, v51, v17, v17
    v_rcp_f32 v50, v50
    v_rcp_f32 v51, v51
    v_mfma_f32_32x32x16_bf16 v[96:111], a[84:87], v[116:119], v[96:111]
    v_mul_f32 v58, v58, v50
    v_mul_f32 v59, v59, v51
    v_cvt_pk_bf16_f32 v49, v58, v59
    v_mul_f32 v61, v53, v61
    v_mul_f32 v52, v16, v52
    v_mul_f32 v53, v16, v53
    v_exp_f32 v52, v52
    v_mfma_f32_32x32x16_bf16 v[64:79], a[88:91], v[120:123], v[64:79]
    v_exp_f32 v53, v53
    v_fma_f32 v52, v52, v17, v17
    v_fma_f32 v53, v53, v17, v17
    v_rcp_f32 v52, v52
    v_mul_f32 v62, v54, v62
    s_waitcnt lgkmcnt(8)
    v_mfma_f32_32x32x16_bf16 v[80:95], a[92:95], v[120:123], v[80:95]
    buffer_load_dwordx4 v[152:155], v2, s[8:11], s53 offen offset:0 sc1
    v_rcp_f32 v53, v53
    v_mul_f32 v60, v60, v52
L_pg4:
    s_cbranch_execz L_ret_w
    v_mul_f32 v61, v61, v53
    v_cvt_pk_bf16_f32 v50, v60, v61
    v_mul_f32 v63, v55, v63
    v_mfma_f32_32x32x16_bf16 v[96:111], a[96:99], v[120:123], v[96:111]
    ds_read_b64_tr_b16 a[120:121], v11 offset:16384
    ds_read_b64_tr_b16 a[122:123], v11 offset:17408
    buffer_load_dwordx4 v[156:159], v2, s[8:11], s54 offen offset:0 sc1
    v_mul_f32 v54, v16, v54
    v_mul_f32 v55, v16, v55
    v_exp_f32 v54, v54
    v_mfma_f32_32x32x16_bf16 v[64:79], a[100:103], v[124:127], v[64:79]
    ds_read_b64_tr_b16 a[124:125], v9 offset:20480
    ds_read_b64_tr_b16 a[126:127], v9 offset:21504
    buffer_load_dwordx4 v[160:163], v2, s[8:11], s55 offen offset:0 sc1
    v_exp_f32 v55, v55
    v_fma_f32 v54, v54, v17, v17
    s_waitcnt lgkmcnt(6)
    v_mfma_f32_32x32x16_bf16 v[80:95], a[104:107], v[124:127], v[80:95]
    ds_read_b64_tr_b16 a[128:129], v10 offset:20480
    ds_read_b64_tr_b16 a[130:131], v10 offset:21504
    v_fma_f32 v55, v55, v17, v17
    v_rcp_f32 v54, v54
    v_rcp_f32 v55, v55
    v_mul_f32 v62, v62, v54
    v_mfma_f32_32x32x16_bf16 v[96:111], a[108:111], v[124:127], v[96:111]
    ds_read_b64_tr_b16 a[132:133], v11 offset:20480
    ds_read_b64_tr_b16 a[134:135], v11 offset:21504
    v_mul_f32 v63, v63, v55
    v_cvt_pk_bf16_f32 v51, v62, v63
    buffer_store_dwordx4 v[48:51], v2, s[8:11], s52 offen offset:2048 sc1
    s_waitcnt vmcnt(14)
    v_mfma_f32_32x32x16_bf16 v[64:79], a[112:115], a[208:211], v[64:79]
    ds_read_b64_tr_b16 a[136:137], v9 offset:24576
    ds_read_b64_tr_b16 a[138:139], v9 offset:25600
    s_and_b32 s39, s36, 3
    s_lshr_b32 s44, s36, 2
    s_lshl2_add_u32 s44, s39, s44
    s_waitcnt lgkmcnt(6)
    v_mfma_f32_32x32x16_bf16 v[80:95], a[116:119], a[208:211], v[80:95]
    ds_read_b64_tr_b16 a[140:141], v10 offset:24576
    ds_read_b64_tr_b16 a[142:143], v10 offset:25600
    s_lshl_b32 s39, s44, 11
    s_add_u32 s45, s39, s101
    v_mfma_f32_32x32x16_bf16 v[96:111], a[120:123], a[208:211], v[96:111]
    ds_read_b64_tr_b16 a[144:145], v11 offset:24576
    ds_read_b64_tr_b16 a[146:147], v11 offset:25600
    buffer_load_dwordx4 v[248:251], v2, s[8:11], s45 offen offset:0 sc1
    ds_read_b64_tr_b16 a[148:149], v9 offset:28672
    ds_read_b64_tr_b16 a[150:151], v9 offset:29696
    v_mfma_f32_32x32x16_bf16 v[64:79], a[124:127], a[212:215], v[64:79]
    buffer_load_dwordx4 v[252:255], v2, s[8:11], s45 offen offset:1024 sc1
    ds_read_b64_tr_b16 a[152:153], v10 offset:28672
    ds_read_b64_tr_b16 a[154:155], v10 offset:29696
    s_waitcnt lgkmcnt(8)
    v_mfma_f32_32x32x16_bf16 v[80:95], a[128:131], a[212:215], v[80:95]
    ds_read_b64_tr_b16 a[156:157], v11 offset:28672
    ds_read_b64_tr_b16 a[158:159], v11 offset:29696
    v_mfma_f32_32x32x16_bf16 v[96:111], a[132:135], a[212:215], v[96:111]
    ds_read_b64_tr_b16 a[160:161], v9 offset:32768
    ds_read_b64_tr_b16 a[162:163], v9 offset:33792
    ds_read_b64_tr_b16 a[164:165], v10 offset:32768
    ds_read_b64_tr_b16 a[166:167], v10 offset:33792
    v_mfma_f32_32x32x16_bf16 v[64:79], a[136:139], a[216:219], v[64:79]
    s_waitcnt lgkmcnt(6)
    ds_read_b64_tr_b16 a[168:169], v11 offset:32768
    ds_read_b64_tr_b16 a[170:171], v11 offset:33792
    ds_read_b64_tr_b16 a[172:173], v9 offset:36864
    ds_read_b64_tr_b16 a[174:175], v9 offset:37888
    v_mfma_f32_32x32x16_bf16 v[80:95], a[140:143], a[216:219], v[80:95]
    ds_read_b64_tr_b16 a[176:177], v10 offset:36864
    ds_read_b64_tr_b16 a[178:179], v10 offset:37888
    v_mfma_f32_32x32x16_bf16 v[96:111], a[144:147], a[216:219], v[96:111]
    ds_read_b64_tr_b16 a[180:181], v11 offset:36864
    ds_read_b64_tr_b16 a[182:183], v11 offset:37888
    s_waitcnt lgkmcnt(6)
    ds_read_b64_tr_b16 a[184:185], v9 offset:40960
    ds_read_b64_tr_b16 a[186:187], v9 offset:41984
    s_waitcnt vmcnt(13)
    v_mfma_f32_32x32x16_bf16 v[64:79], a[148:151], a[220:223], v[64:79]
    ds_read_b64_tr_b16 a[188:189], v10 offset:40960
    ds_read_b64_tr_b16 a[190:191], v10 offset:41984
    ds_read_b64_tr_b16 a[192:193], v11 offset:40960
    ds_read_b64_tr_b16 a[194:195], v11 offset:41984
    v_mfma_f32_32x32x16_bf16 v[80:95], a[152:155], a[220:223], v[80:95]
    ds_read_b64_tr_b16 a[196:197], v9 offset:45056
    ds_read_b64_tr_b16 a[198:199], v9 offset:46080
    v_mfma_f32_32x32x16_bf16 v[96:111], a[156:159], a[220:223], v[96:111]
    s_waitcnt lgkmcnt(6)
    ds_read_b64_tr_b16 a[200:201], v10 offset:45056
    ds_read_b64_tr_b16 a[202:203], v10 offset:46080
    ds_read_b64_tr_b16 a[204:205], v11 offset:45056
    ds_read_b64_tr_b16 a[206:207], v11 offset:46080
    v_mfma_f32_32x32x16_bf16 v[64:79], a[160:163], a[224:227], v[64:79]
    ds_read_b64_tr_b16 a[0:1], v10 offset:49152
    ds_read_b64_tr_b16 a[2:3], v10 offset:50176
    ds_read_b64_tr_b16 a[4:5], v10 offset:53248
    ds_read_b64_tr_b16 a[6:7], v10 offset:54272
    v_mfma_f32_32x32x16_bf16 v[80:95], a[164:167], a[224:227], v[80:95]
    s_waitcnt lgkmcnt(6)
    ds_read_b64_tr_b16 a[8:9], v10 offset:57344
    ds_read_b64_tr_b16 a[10:11], v10 offset:58368
    v_mfma_f32_32x32x16_bf16 v[96:111], a[168:171], a[224:227], v[96:111]
    buffer_load_dwordx4 v[164:167], v2, s[8:11], s53 offen offset:1024 sc1
    ds_read_b64_tr_b16 a[12:13], v10 offset:61440
    ds_read_b64_tr_b16 a[14:15], v10 offset:62464
    v_mfma_f32_32x32x16_bf16 v[64:79], a[172:175], a[228:231], v[64:79]
    s_waitcnt vmcnt(11)
    v_max3_u32 v31, v128, v132, v136
    v_cmp_eq_u32 vcc, -1, v31
    buffer_load_dwordx4 v[168:171], v2, s[8:11], s54 offen offset:1024 sc1
    v_mfma_f32_32x32x16_bf16 v[80:95], a[176:179], a[228:231], v[80:95]
    s_cbranch_vccnz L_g2_slow
L_g2_ok:
    buffer_load_dwordx4 v[172:175], v2, s[8:11], s55 offen offset:1024 sc1
    v_mfma_f32_32x32x16_bf16 v[96:111], a[180:183], a[228:231], v[96:111]
    v_mfma_f32_32x32x16_bf16 v[64:79], a[184:187], v[128:131], v[64:79]
    s_barrier
    v_add_u32 v10, 0x10000, v10
    ds_read_b64_tr_b16 a[16:17], v10 offset:0
    ds_read_b64_tr_b16 a[18:19], v10 offset:1024
    v_mfma_f32_32x32x16_bf16 v[80:95], a[188:191], v[128:131], v[80:95]
    ds_read_b64_tr_b16 a[20:21], v10 offset:4096
    ds_read_b64_tr_b16 a[22:23], v10 offset:5120
    v_mfma_f32_32x32x16_bf16 v[96:111], a[192:195], v[128:131], v[96:111]
    s_waitcnt lgkmcnt(6)
    ds_read_b64_tr_b16 a[24:25], v10 offset:8192
    ds_read_b64_tr_b16 a[26:27], v10 offset:9216
    ds_read_b64_tr_b16 a[28:29], v10 offset:12288
    ds_read_b64_tr_b16 a[30:31], v10 offset:13312
    v_mfma_f32_32x32x16_bf16 v[64:79], a[196:199], v[132:135], v[64:79]
    ds_read_b64_tr_b16 a[32:33], v10 offset:16384
    ds_read_b64_tr_b16 a[34:35], v10 offset:17408
    ds_read_b64_tr_b16 a[36:37], v10 offset:20480
    ds_read_b64_tr_b16 a[38:39], v10 offset:21504
    v_mfma_f32_32x32x16_bf16 v[80:95], a[200:203], v[132:135], v[80:95]
    s_waitcnt vmcnt(9)
    v_max3_u32 v31, v140, v144, v148
    v_cmp_eq_u32 vcc, -1, v31
    s_waitcnt lgkmcnt(6)
    ds_read_b64_tr_b16 a[40:41], v10 offset:24576
    ds_read_b64_tr_b16 a[42:43], v10 offset:25600
    v_mfma_f32_32x32x16_bf16 v[96:111], a[204:207], v[132:135], v[96:111]
    s_cbranch_vccnz L_g3_slow
L_g3_ok:
    ds_read_b64_tr_b16 a[44:45], v10 offset:28672
    ds_read_b64_tr_b16 a[46:47], v10 offset:29696
    ds_read_b64_tr_b16 a[48:49], v11 offset:49152
    ds_read_b64_tr_b16 a[50:51], v11 offset:50176
    v_mfma_f32_32x32x16_bf16 v[80:95], a[0:3], v[136:139], v[80:95]
    ds_read_b64_tr_b16 a[52:53], v11 offset:53248
    ds_read_b64_tr_b16 a[54:55], v11 offset:54272
    s_waitcnt lgkmcnt(6)
    ds_read_b64_tr_b16 a[56:57], v11 offset:57344
    ds_read_b64_tr_b16 a[58:59], v11 offset:58368
    v_mfma_f32_32x32x16_bf16 v[80:95], a[4:7], v[140:143], v[80:95]
    ds_read_b64_tr_b16 a[60:61], v11 offset:61440
    ds_read_b64_tr_b16 a[62:63], v11 offset:62464
    v_mfma_f32_32x32x16_bf16 v[80:95], a[8:11], v[144:147], v[80:95]
    s_waitcnt vmcnt(6)
    v_max3_u32 v31, v152, v156, v160
    v_cmp_eq_u32 vcc, -1, v31
    v_add_u32 v11, 0x10000, v11
    ds_read_b64_tr_b16 a[64:65], v11 offset:0
    ds_read_b64_tr_b16 a[66:67], v11 offset:1024
    v_mfma_f32_32x32x16_bf16 v[80:95], a[12:15], v[148:151], v[80:95]
    s_cbranch_vccnz L_gX_slow
L_gX_ok:
    ds_read_b64_tr_b16 a[68:69], v11 offset:4096
    ds_read_b64_tr_b16 a[70:71], v11 offset:5120
    s_waitcnt lgkmcnt(6)
    ds_read_b64_tr_b16 a[72:73], v11 offset:8192
    ds_read_b64_tr_b16 a[74:75], v11 offset:9216
    v_mfma_f32_32x32x16_bf16 v[80:95], a[16:19], v[22:25], v[80:95]
    ds_read_b64_tr_b16 a[76:77], v11 offset:12288
    ds_read_b64_tr_b16 a[78:79], v11 offset:13312
    v_mfma_f32_32x32x16_bf16 v[80:95], a[20:23], v[152:155], v[80:95]
    ds_read_b64_tr_b16 a[80:81], v11 offset:16384
    ds_read_b64_tr_b16 a[82:83], v11 offset:17408
    ds_read_b64_tr_b16 a[84:85], v11 offset:20480
    ds_read_b64_tr_b16 a[86:87], v11 offset:21504
    v_mfma_f32_32x32x16_bf16 v[80:95], a[24:27], v[156:159], v[80:95]
    s_waitcnt vmcnt(0)
    v_max3_u32 v31, v164, v168, v172
    v_cmp_eq_u32 vcc, -1, v31
    buffer_load_dwordx4 v[176:179], v2, s[8:11], s53 offen offset:2048 sc1
    v_mfma_f32_32x32x16_bf16 v[80:95], a[28:31], v[160:163], v[80:95]
    s_cbranch_vccnz L_gY_slow
L_gY_ok:
    buffer_load_dwordx4 v[180:183], v2, s[8:11], s54 offen offset:2048 sc1
    s_waitcnt lgkmcnt(6)
    ds_read_b64_tr_b16 a[88:89], v11 offset:24576
    ds_read_b64_tr_b16 a[90:91], v11 offset:25600
    v_mfma_f32_32x32x16_bf16 v[80:95], a[32:35], v[32:35], v[80:95]
    buffer_load_dwordx4 v[184:187], v2, s[8:11], s55 offen offset:2048 sc1
    ds_read_b64_tr_b16 a[92:93], v11 offset:28672
    ds_read_b64_tr_b16 a[94:95], v11 offset:29696
    ds_read_b64_tr_b16 a[96:97], v9 offset:49152
    ds_read_b64_tr_b16 a[98:99], v9 offset:50176
    v_mfma_f32_32x32x16_bf16 v[80:95], a[36:39], v[164:167], v[80:95]
    buffer_load_dwordx4 v[188:191], v2, s[8:11], s92 offen offset:2048 sc1
    ds_read_b64_tr_b16 a[100:101], v9 offset:53248
    ds_read_b64_tr_b16 a[102:103], v9 offset:54272
    s_waitcnt lgkmcnt(6)
    ds_read_b64_tr_b16 a[104:105], v9 offset:57344
    ds_read_b64_tr_b16 a[106:107], v9 offset:58368
    v_mfma_f32_32x32x16_bf16 v[80:95], a[40:43], v[168:171], v[80:95]
    buffer_load_dwordx4 v[192:195], v2, s[8:11], s93 offen offset:2048 sc1
    ds_read_b64_tr_b16 a[108:109], v9 offset:61440
    ds_read_b64_tr_b16 a[110:111], v9 offset:62464
    v_mfma_f32_32x32x16_bf16 v[80:95], a[44:47], v[172:175], v[80:95]
    buffer_load_dwordx4 v[196:199], v2, s[8:11], s94 offen offset:2048 sc1
    v_add_u32 v9, 0x10000, v9
    ds_read_b64_tr_b16 a[112:113], v9 offset:0
    ds_read_b64_tr_b16 a[114:115], v9 offset:1024
    v_mfma_f32_32x32x16_bf16 v[96:111], a[48:51], v[136:139], v[96:111]
    buffer_load_dwordx4 v[200:203], v2, s[8:11], s95 offen offset:2048 sc1
    s_xor_b32 s98, s36, 8
    s_sub_i32 s98, s98, s36
    s_mul_i32 s98, s98, 6144
    s_add_u32 s98, s98, s65
    v_mfma_f32_32x32x16_bf16 v[96:111], a[52:55], v[140:143], v[96:111]
    s_add_u32 s98, s98, 2048
    v_cvt_pk_bf16_f32 v80, v80, v81
    v_and_or_b32 v80, v80, s29, v21
    v_cvt_pk_bf16_f32 v81, v82, v83
    v_and_or_b32 v81, v81, s29, v21
    v_mfma_f32_32x32x16_bf16 v[96:111], a[56:59], v[144:147], v[96:111]
    v_cvt_pk_bf16_f32 v82, v84, v85
    v_and_or_b32 v82, v82, s29, v21
    v_cvt_pk_bf16_f32 v83, v86, v87
    v_and_or_b32 v83, v83, s29, v21
    v_mfma_f32_32x32x16_bf16 v[96:111], a[60:63], v[148:151], v[96:111]
    buffer_store_dwordx4 v[80:83], v2, s[8:11], s98 offen offset:0 sc1
    v_mfma_f32_32x32x16_bf16 v[96:111], a[64:67], v[22:25], v[96:111]
    v_cvt_pk_bf16_f32 v88, v88, v89
    v_and_or_b32 v88, v88, s29, v21
    v_cvt_pk_bf16_f32 v89, v90, v91
    v_and_or_b32 v89, v89, s29, v21
    v_cvt_pk_bf16_f32 v90, v92, v93
    v_mfma_f32_32x32x16_bf16 v[96:111], a[68:71], v[152:155], v[96:111]
    v_and_or_b32 v90, v90, s29, v21
    v_cvt_pk_bf16_f32 v91, v94, v95
    v_and_or_b32 v91, v91, s29, v21
    ds_read_b64_tr_b16 a[116:117], v9 offset:4096
    ds_read_b64_tr_b16 a[118:119], v9 offset:5120
    v_mfma_f32_32x32x16_bf16 v[96:111], a[72:75], v[156:159], v[96:111]
    buffer_store_dwordx4 v[88:91], v2, s[8:11], s98 offen offset:1024 sc1
    v_mfma_f32_32x32x16_bf16 v[96:111], a[76:79], v[160:163], v[96:111]
    s_waitcnt lgkmcnt(6)
    ds_read_b64_tr_b16 a[120:121], v9 offset:8192
    ds_read_b64_tr_b16 a[122:123], v9 offset:9216
    v_mfma_f32_32x32x16_bf16 v[96:111], a[80:83], v[32:35], v[96:111]
    ds_read_b64_tr_b16 a[124:125], v9 offset:12288
    ds_read_b64_tr_b16 a[126:127], v9 offset:13312
    ds_read_b64_tr_b16 a[128:129], v9 offset:16384
    ds_read_b64_tr_b16 a[130:131], v9 offset:17408
    v_mfma_f32_32x32x16_bf16 v[96:111], a[84:87], v[164:167], v[96:111]
    ds_read_b64_tr_b16 a[132:133], v9 offset:20480
    ds_read_b64_tr_b16 a[134:135], v9 offset:21504
    s_waitcnt lgkmcnt(6)
    ds_read_b64_tr_b16 a[136:137], v9 offset:24576
    ds_read_b64_tr_b16 a[138:139], v9 offset:25600
    v_mfma_f32_32x32x16_bf16 v[96:111], a[88:91], v[168:171], v[96:111]
    ds_read_b64_tr_b16 a[140:141], v9 offset:28672
    ds_read_b64_tr_b16 a[142:143], v9 offset:29696
    v_mfma_f32_32x32x16_bf16 v[96:111], a[92:95], v[172:175], v[96:111]
    v_add_u32 v9, 0xfffe0000, v9
    ds_read_b64_tr_b16 a[144:145], v9 offset:0
    ds_read_b64_tr_b16 a[146:147], v9 offset:1024
    v_add_u32 v11, 0xfffe0000, v11
    ds_read_b64_tr_b16 a[148:149], v11 offset:0
    ds_read_b64_tr_b16 a[150:151], v11 offset:1024
    v_mfma_f32_32x32x16_bf16 v[64:79], a[96:99], v[136:139], v[64:79]
    s_xor_b32 s98, s36, 12
    s_sub_i32 s98, s98, s36
    s_mul_i32 s98, s98, 6144
    s_add_u32 s98, s98, s65
    s_add_u32 s98, s98, 4096
    v_cvt_pk_bf16_f32 v96, v96, v97
    v_mfma_f32_32x32x16_bf16 v[64:79], a[100:103], v[140:143], v[64:79]
    v_and_or_b32 v96, v96, s29, v21
    v_cvt_pk_bf16_f32 v97, v98, v99
    v_and_or_b32 v97, v97, s29, v21
    v_cvt_pk_bf16_f32 v98, v100, v101
    v_and_or_b32 v98, v98, s29, v21
    v_mfma_f32_32x32x16_bf16 v[64:79], a[104:107], v[144:147], v[64:79]
    v_cvt_pk_bf16_f32 v99, v102, v103
    v_and_or_b32 v99, v99, s29, v21
    buffer_store_dwordx4 v[96:99], v2, s[8:11], s98 offen offset:0 sc1
    v_mfma_f32_32x32x16_bf16 v[64:79], a[108:111], v[148:151], v[64:79]
    v_cvt_pk_bf16_f32 v104, v104, v105
    v_and_or_b32 v104, v104, s29, v21
    v_cvt_pk_bf16_f32 v105, v106, v107
    v_and_or_b32 v105, v105, s29, v21
    v_cvt_pk_bf16_f32 v106, v108, v109
    v_mfma_f32_32x32x16_bf16 v[64:79], a[112:115], v[22:25], v[64:79]
    v_and_or_b32 v106, v106, s29, v21
    v_cvt_pk_bf16_f32 v107, v110, v111
    v_and_or_b32 v107, v107, s29, v21
    s_waitcnt lgkmcnt(6)
    ds_read_b64_tr_b16 a[152:153], v9 offset:4096
    ds_read_b64_tr_b16 a[154:155], v9 offset:5120
    v_mfma_f32_32x32x16_bf16 v[64:79], a[116:119], v[152:155], v[64:79]
    buffer_store_dwordx4 v[104:107], v2, s[8:11], s98 offen offset:1024 sc1
    v_mfma_f32_32x32x16_bf16 v[64:79], a[120:123], v[156:159], v[64:79]
    ds_read_b64_tr_b16 a[156:157], v11 offset:4096
    ds_read_b64_tr_b16 a[158:159], v11 offset:5120
    ds_read_b64_tr_b16 a[160:161], v9 offset:8192
    ds_read_b64_tr_b16 a[162:163], v9 offset:9216
    v_mfma_f32_32x32x16_bf16 v[64:79], a[124:127], v[160:163], v[64:79]
    ds_read_b64_tr_b16 a[164:165], v11 offset:8192
    ds_read_b64_tr_b16 a[166:167], v11 offset:9216
    v_mfma_f32_32x32x16_bf16 v[64:79], a[128:131], v[32:35], v[64:79]
    s_waitcnt lgkmcnt(6)
    ds_read_b64_tr_b16 a[168:169], v9 offset:12288
    ds_read_b64_tr_b16 a[170:171], v9 offset:13312
    ds_read_b64_tr_b16 a[172:173], v11 offset:12288
    ds_read_b64_tr_b16 a[174:175], v11 offset:13312
    v_mfma_f32_32x32x16_bf16 v[64:79], a[132:135], v[164:167], v[64:79]
    ds_read_b64_tr_b16 a[176:177], v8 offset:0
    ds_read_b64_tr_b16 a[178:179], v8 offset:1024
    ds_read_b64_tr_b16 a[180:181], v8 offset:4096
    ds_read_b64_tr_b16 a[182:183], v8 offset:5120
    v_mfma_f32_32x32x16_bf16 v[64:79], a[136:139], v[168:171], v[64:79]
    s_waitcnt vmcnt(4)
    v_max3_u32 v31, v176, v180, v184
    v_max3_u32 v31, v31, v188, v192
    v_max3_u32 v31, v31, v196, v200
    v_cmp_eq_u32 vcc, -1, v31
    v_mfma_f32_32x32x16_bf16 v[64:79], a[140:143], v[172:175], v[64:79]
    s_cbranch_vccnz L_gZ_slow
L_gZ_ok:
    v_mov_b32 v224, v6
    v_mov_b32 v225, v6
    v_mov_b32 v226, v6
    v_mov_b32 v227, v6
    v_mov_b32 v228, v6
    v_mfma_f32_32x32x16_bf16 v[64:79], a[144:147], v[48:51], v[64:79]
    v_mov_b32 v229, v6
    v_mov_b32 v230, v6
    v_mov_b32 v231, v6
    v_mov_b32 v232, v6
    v_mov_b32 v233, v6
    v_mov_b32 v234, v6
    v_mfma_f32_32x32x16_bf16 v[64:79], a[148:151], v[188:191], v[64:79]
    v_mov_b32 v235, v6
    v_mov_b32 v236, v6
    v_mov_b32 v237, v6
    v_mov_b32 v238, v6
    v_mov_b32 v239, v6
    v_mfma_f32_32x32x16_bf16 v[64:79], a[152:155], v[176:179], v[64:79]
    s_waitcnt lgkmcnt(6)
    ds_read_b64_tr_b16 a[184:185], v8 offset:8192
    ds_read_b64_tr_b16 a[186:187], v8 offset:9216
    ds_read_b64_tr_b16 a[188:189], v8 offset:12288
    ds_read_b64_tr_b16 a[190:191], v8 offset:13312
    v_mfma_f32_32x32x16_bf16 v[64:79], a[156:159], v[192:195], v[64:79]
    ds_read_b64_tr_b16 a[192:193], v8 offset:16384
    ds_read_b64_tr_b16 a[194:195], v8 offset:17408
    ds_read_b64_tr_b16 a[196:197], v8 offset:20480
    ds_read_b64_tr_b16 a[198:199], v8 offset:21504
    v_mfma_f32_32x32x16_bf16 v[64:79], a[160:163], v[180:183], v[64:79]
    s_waitcnt lgkmcnt(6)
    ds_read_b64_tr_b16 a[200:201], v8 offset:24576
    ds_read_b64_tr_b16 a[202:203], v8 offset:25600
    v_mfma_f32_32x32x16_bf16 v[64:79], a[164:167], v[196:199], v[64:79]
    ds_read_b64_tr_b16 a[204:205], v8 offset:28672
    ds_read_b64_tr_b16 a[206:207], v8 offset:29696
    ds_read_b64_tr_b16 a[0:1], v8 offset:32768
    ds_read_b64_tr_b16 a[2:3], v8 offset:33792
    v_mfma_f32_32x32x16_bf16 v[64:79], a[168:171], v[184:187], v[64:79]
    ds_read_b64_tr_b16 a[4:5], v8 offset:36864
    ds_read_b64_tr_b16 a[6:7], v8 offset:37888
    s_waitcnt lgkmcnt(6)
    ds_read_b64_tr_b16 a[8:9], v8 offset:40960
    ds_read_b64_tr_b16 a[10:11], v8 offset:41984
    v_mfma_f32_32x32x16_bf16 v[64:79], a[172:175], v[200:203], v[64:79]
    ds_read_b64_tr_b16 a[12:13], v8 offset:45056
    ds_read_b64_tr_b16 a[14:15], v8 offset:46080
    v_mfma_f32_32x32x16_bf16 v[224:239], a[176:179], v[112:115], v[224:239]
    s_xor_b32 s98, s36, 4
    s_sub_i32 s98, s98, s36
    s_mul_i32 s98, s98, 6144
    s_add_u32 s98, s98, s65
    s_add_u32 s98, s98, 0
    s_nop 3
    v_cvt_pk_bf16_f32 v64, v64, v65
    v_mfma_f32_32x32x16_bf16 v[224:239], a[180:183], v[116:119], v[224:239]
    v_and_or_b32 v64, v64, s29, v21
    v_cvt_pk_bf16_f32 v65, v66, v67
    v_and_or_b32 v65, v65, s29, v21
    v_cvt_pk_bf16_f32 v66, v68, v69
    v_and_or_b32 v66, v66, s29, v21
    v_mfma_f32_32x32x16_bf16 v[224:239], a[184:187], v[120:123], v[224:239]
    v_cvt_pk_bf16_f32 v67, v70, v71
    v_and_or_b32 v67, v67, s29, v21
    buffer_store_dwordx4 v[64:67], v2, s[8:11], s98 offen offset:0 sc1
    v_mfma_f32_32x32x16_bf16 v[224:239], a[188:191], v[124:127], v[224:239]
    v_cvt_pk_bf16_f32 v72, v72, v73
    v_and_or_b32 v72, v72, s29, v21
    v_cvt_pk_bf16_f32 v73, v74, v75
    v_and_or_b32 v73, v73, s29, v21
    v_cvt_pk_bf16_f32 v74, v76, v77
    v_mfma_f32_32x32x16_bf16 v[224:239], a[192:195], a[208:211], v[224:239]
    v_and_or_b32 v74, v74, s29, v21
    v_cvt_pk_bf16_f32 v75, v78, v79
    v_and_or_b32 v75, v75, s29, v21
    ds_read_b64_tr_b16 a[16:17], v8 offset:49152
    ds_read_b64_tr_b16 a[18:19], v8 offset:50176
    v_mfma_f32_32x32x16_bf16 v[224:239], a[196:199], a[212:215], v[224:239]
    buffer_store_dwordx4 v[72:75], v2, s[8:11], s98 offen offset:1024 sc1
    s_lshl_b32 s44, s44, 6
    v_mfma_f32_32x32x16_bf16 v[224:239], a[200:203], a[216:219], v[224:239]
    v_bfe_u32 v26, v1, 2, 1
    v_cmp_eq_u32 s[30:31], v26, v4
    v_and_b32 v26, 1, v1
    v_lshlrev_b32 v26, 4, v26
    s_waitcnt lgkmcnt(6)
    v_mfma_f32_32x32x16_bf16 v[224:239], a[204:207], a[220:223], v[224:239]
    ds_read_b64_tr_b16 a[20:21], v8 offset:53248
    ds_read_b64_tr_b16 a[22:23], v8 offset:54272
    v_mov_b32 v27, 0x3f80
    v_lshlrev_b32 v26, v26, v27
    v_cndmask_b32 v26, 0, v26, s[30:31]
    v_mfma_f32_32x32x16_bf16 v[224:239], a[0:3], a[224:227], v[224:239]
    ds_read_b64_tr_b16 a[24:25], v8 offset:57344
    ds_read_b64_tr_b16 a[26:27], v8 offset:58368
    v_bfe_u32 v27, v1, 1, 1
    v_bfe_u32 v240, v1, 3, 2
    v_lshl_or_b32 v27, v240, 1, v27
    v_mfma_f32_32x32x16_bf16 v[224:239], a[4:7], a[228:231], v[224:239]
    ds_read_b64_tr_b16 a[28:29], v8 offset:61440
    ds_read_b64_tr_b16 a[30:31], v8 offset:62464
    v_lshl_add_u32 v5, v4, 4, v7
    s_lshl_b32 s39, s32, 11
    s_add_u32 s39, s39, 32768
    s_waitcnt lgkmcnt(6)
    v_mfma_f32_32x32x16_bf16 v[224:239], a[8:11], v[128:131], v[224:239]
    v_add_u32 v8, 0x10000, v8
    ds_read_b64_tr_b16 a[32:33], v8 offset:0
    ds_read_b64_tr_b16 a[34:35], v8 offset:1024
    v_bfe_u32 v16, v3, 1, 2
    v_xor_b32 v16, v16, v4
    v_lshlrev_b32 v16, 4, v16
    v_mfma_f32_32x32x16_bf16 v[224:239], a[12:15], v[132:135], v[224:239]
    ds_read_b64_tr_b16 a[36:37], v8 offset:4096
    ds_read_b64_tr_b16 a[38:39], v8 offset:5120
    v_lshl_add_u32 v16, v3, 6, v16
    v_add_u32 v16, s39, v16
    v_xor_b32 v17, 32, v16
    v_add_u32 v220, s39, v2
    v_mfma_f32_32x32x16_bf16 v[224:239], a[16:19], v[136:139], v[224:239]
    ds_read_b64_tr_b16 a[40:41], v8 offset:8192
    ds_read_b64_tr_b16 a[42:43], v8 offset:9216
    v_bfe_u32 v221, v1, 3, 2
    v_xor_b32 v221, v221, v1
    v_and_b32 v221, 3, v221
    s_waitcnt lgkmcnt(6)
    v_mfma_f32_32x32x16_bf16 v[224:239], a[20:23], v[140:143], v[224:239]
    ds_read_b64_tr_b16 a[44:45], v8 offset:12288
    ds_read_b64_tr_b16 a[46:47], v8 offset:13312
    v_lshrrev_b32 v222, 2, v1
    v_sub_u32 v222, v222, v3
    v_lshl_add_u32 v5, v222, 15, v7
    v_lshl_add_u32 v5, v221, 4, v5
    v_mfma_f32_32x32x16_bf16 v[224:239], a[24:27], v[144:147], v[224:239]
    buffer_load_dwordx4 v[204:207], v2, s[8:11], s65 offen offset:2048 sc1
    buffer_load_dwordx4 v[208:211], v2, s[8:11], s65 offen offset:3072 sc1
    ds_read_b64_tr_b16 a[48:49], v8 offset:16384
    ds_read_b64_tr_b16 a[50:51], v8 offset:17408
    v_mfma_f32_32x32x16_bf16 v[224:239], a[28:31], v[148:151], v[224:239]
    ds_read_b64_tr_b16 a[52:53], v8 offset:20480
    ds_read_b64_tr_b16 a[54:55], v8 offset:21504
    s_add_u32 s28, s44, 524288
    v_cmp_eq_u32 s[30:31], 0, v27
    v_cmp_eq_u32 s[60:61], 1, v27
    s_waitcnt lgkmcnt(6)
    v_mfma_f32_32x32x16_bf16 v[224:239], a[32:35], v[22:25], v[224:239]
    ds_read_b64_tr_b16 a[56:57], v8 offset:24576
    ds_read_b64_tr_b16 a[58:59], v8 offset:25600
    v_cmp_eq_u32 s[62:63], 2, v27
    v_cndmask_b32 v240, 0, v26, s[30:31]
    v_cmp_eq_u32 s[30:31], 3, v27
    v_mfma_f32_32x32x16_bf16 v[224:239], a[36:39], v[152:155], v[224:239]
    ds_read_b64_tr_b16 a[60:61], v8 offset:28672
    ds_read_b64_tr_b16 a[62:63], v8 offset:29696
    v_cndmask_b32 v241, 0, v26, s[60:61]
    v_cmp_eq_u32 s[60:61], 4, v27
    v_cndmask_b32 v242, 0, v26, s[62:63]
    v_mfma_f32_32x32x16_bf16 v[224:239], a[40:43], v[156:159], v[224:239]
    v_add_u32 v8, 0xfffe0000, v8
    ds_read_b64_tr_b16 a[64:65], v8 offset:0
    ds_read_b64_tr_b16 a[66:67], v8 offset:1024
    v_cmp_eq_u32 s[62:63], 5, v27
    s_waitcnt lgkmcnt(6)
    v_mfma_f32_32x32x16_bf16 v[224:239], a[44:47], v[160:163], v[224:239]
    v_add_u32 v10, 0xfffe0000, v10
    ds_read_b64_tr_b16 a[68:69], v10 offset:0
    ds_read_b64_tr_b16 a[70:71], v10 offset:1024
    v_cndmask_b32 v243, 0, v26, s[30:31]
    v_cmp_eq_u32 s[30:31], 6, v27
    v_mfma_f32_32x32x16_bf16 v[224:239], a[48:51], v[32:35], v[224:239]
    ds_read_b64_tr_b16 a[72:73], v8 offset:4096
    ds_read_b64_tr_b16 a[74:75], v8 offset:5120
    v_cndmask_b32 v244, 0, v26, s[60:61]
    v_cmp_eq_u32 s[60:61], 7, v27
    v_cndmask_b32 v245, 0, v26, s[62:63]
    v_mfma_f32_32x32x16_bf16 v[224:239], a[52:55], v[164:167], v[224:239]
    ds_read_b64_tr_b16 a[76:77], v10 offset:4096
    ds_read_b64_tr_b16 a[78:79], v10 offset:5120
    v_cndmask_b32 v246, 0, v26, s[30:31]
    v_cndmask_b32 v247, 0, v26, s[60:61]
    s_waitcnt lgkmcnt(6)
    v_mfma_f32_32x32x16_bf16 v[224:239], a[56:59], v[168:171], v[224:239]
    ds_read_b64_tr_b16 a[80:81], v8 offset:8192
    ds_read_b64_tr_b16 a[82:83], v8 offset:9216
    ds_read_b64_tr_b16 a[84:85], v10 offset:8192
    ds_read_b64_tr_b16 a[86:87], v10 offset:9216
    v_mfma_f32_32x32x16_bf16 v[224:239], a[60:63], v[172:175], v[224:239]
    ds_read_b64_tr_b16 a[88:89], v8 offset:12288
    ds_read_b64_tr_b16 a[90:91], v8 offset:13312
    v_mfma_f32_32x32x16_bf16 v[224:239], a[64:67], v[48:51], v[224:239]
    ds_read_b64_tr_b16 a[92:93], v10 offset:12288
    ds_read_b64_tr_b16 a[94:95], v10 offset:13312
    s_waitcnt lgkmcnt(8)
    v_mfma_f32_32x32x16_bf16 v[224:239], a[68:71], v[188:191], v[224:239]
    buffer_load_dwordx4 v[212:215], v2, s[8:11], s3 offen offset:0 sc1
    buffer_load_dwordx4 v[216:219], v2, s[8:11], s3 offen offset:1024 sc1
    v_mfma_f32_32x32x16_bf16 v[224:239], a[72:75], v[176:179], v[224:239]
    v_mfma_f32_32x32x16_bf16 v[224:239], a[76:79], v[192:195], v[224:239]
    s_waitcnt lgkmcnt(2)
    v_mfma_f32_32x32x16_bf16 v[224:239], a[80:83], v[180:183], v[224:239]
    v_mfma_f32_32x32x16_bf16 v[224:239], a[84:87], v[196:199], v[224:239]
    v_mfma_f32_32x32x16_bf16 v[224:239], a[88:91], v[184:187], v[224:239]
    s_waitcnt lgkmcnt(0)
    v_mfma_f32_32x32x16_bf16 v[224:239], a[92:95], v[200:203], v[224:239]
    s_waitcnt vmcnt(4)
    buffer_load_dwordx4 v[36:39], v2, s[8:11], s65 offen offset:0 sc1
    buffer_load_dwordx4 v[40:43], v2, s[8:11], s65 offen offset:1024 sc1
    v_mfma_f32_32x32x16_bf16 v[224:239], v[240:243], v[248:251], v[224:239]
    v_mfma_f32_32x32x16_bf16 v[224:239], v[244:247], v[252:255], v[224:239]
    s_waitcnt vmcnt(4)
    v_xor_b32 v204, v21, v204
    v_xor_b32 v205, v21, v205
    v_xor_b32 v206, v21, v206
    v_xor_b32 v207, v21, v207
    v_xor_b32 v208, v21, v208
    v_xor_b32 v209, v21, v209
    v_xor_b32 v210, v21, v210
    v_xor_b32 v211, v21, v211
    v_or3_b32 v31, v204, v205, v206
    v_or3_b32 v31, v31, v207, v208
    v_or3_b32 v31, v31, v209, v210
    v_or_b32 v31, v31, v211
    v_and_b32 v31, 0x10001, v31
    v_cmp_ne_u32 vcc, 0, v31
    s_cbranch_vccnz L_pp2_slow
L_pp2_ok:
    v_mfma_f32_32x32x16_bf16 v[224:239], v[240:243], v[204:207], v[224:239]
    v_mfma_f32_32x32x16_bf16 v[224:239], v[244:247], v[208:211], v[224:239]
    s_waitcnt vmcnt(2)
    v_xor_b32 v212, v21, v212
    v_xor_b32 v213, v21, v213
    v_xor_b32 v214, v21, v214
    v_xor_b32 v215, v21, v215
    v_xor_b32 v216, v21, v216
    v_xor_b32 v217, v21, v217
    v_xor_b32 v218, v21, v218
    v_xor_b32 v219, v21, v219
    v_or3_b32 v31, v212, v213, v214
    v_or3_b32 v31, v31, v215, v216
    v_or3_b32 v31, v31, v217, v218
    v_or_b32 v31, v31, v219
    v_and_b32 v31, 0x10001, v31
    v_cmp_ne_u32 vcc, 0, v31
    s_cbranch_vccnz L_pp3_slow
L_pp3_ok:
    v_mfma_f32_32x32x16_bf16 v[224:239], v[240:243], v[212:215], v[224:239]
    v_mfma_f32_32x32x16_bf16 v[224:239], v[244:247], v[216:219], v[224:239]
    s_waitcnt vmcnt(0)
    v_xor_b32 v36, v21, v36
    v_xor_b32 v37, v21, v37
    v_xor_b32 v38, v21, v38
    v_xor_b32 v39, v21, v39
    v_xor_b32 v40, v21, v40
    v_xor_b32 v41, v21, v41
L_pg5:
    s_cbranch_execz L_ret_w
    v_xor_b32 v42, v21, v42
    v_xor_b32 v43, v21, v43
    v_or3_b32 v31, v36, v37, v38
    v_or3_b32 v31, v31, v39, v40
    v_or3_b32 v31, v31, v41, v42
    v_or_b32 v31, v31, v43
    v_and_b32 v31, 0x10001, v31
    v_cmp_ne_u32 vcc, 0, v31
    s_cbranch_vccnz L_pp1_slow
L_pp1_ok:
    v_mfma_f32_32x32x16_bf16 v[224:239], v[240:243], v[36:39], v[224:239]
    v_mfma_f32_32x32x16_bf16 v[224:239], v[244:247], v[40:43], v[224:239]
    s_nop 11
    v_cvt_pk_bf16_f32 v64, v224, v225
    v_cvt_pk_bf16_f32 v65, v226, v227
    v_cvt_pk_bf16_f32 v66, v228, v229
    v_cvt_pk_bf16_f32 v67, v230, v231
    ds_write_b128 v16, v[64:67]
    v_cvt_pk_bf16_f32 v68, v232, v233
    v_cvt_pk_bf16_f32 v69, v234, v235
    v_cvt_pk_bf16_f32 v70, v236, v237
    v_cvt_pk_bf16_f32 v71, v238, v239
    ds_write_b128 v17, v[68:71]
    s_waitcnt lgkmcnt(0)
    ds_read_b128 v[72:75], v220
    ds_read_b128 v[76:79], v220 offset:1024
    s_waitcnt lgkmcnt(1)
    buffer_store_dwordx4 v[72:75], v5, s[24:27], s44 offen
    s_waitcnt lgkmcnt(0)
    buffer_store_dwordx4 v[76:79], v5, s[24:27], s28 offen
L_end:
    s_endpgm
L_ts0:
    s_branch L_ts4
L_p1_slow:
    s_mov_b32 s47, 0
L_p1_lp:
    s_mov_b64 exec, vcc
    buffer_load_dword v76, v81, s[8:11], s43 offen offset:0 sc1
    buffer_load_dword v77, v81, s[8:11], s43 offen offset:128 sc1
    buffer_load_dword v78, v81, s[8:11], s43 offen offset:256 sc1
    buffer_load_dword v79, v81, s[8:11], s43 offen offset:384 sc1
    s_add_u32 s47, s47, 1
    s_waitcnt vmcnt(0)
    v_xor_b32 v76, v30, v76
    v_xor_b32 v77, v30, v77
    v_xor_b32 v78, v30, v78
    v_xor_b32 v79, v30, v79
    v_or_b32 v76, v76, v77
    v_or3_b32 v76, v76, v78, v79
    v_cmp_ne_u32 vcc, 0, v76
    s_cmp_gt_u32 s47, 60000
    s_cbranch_scc1 L_p1_x
    s_cbranch_vccnz L_p1_lp
L_p1_x:
    s_mov_b64 exec, -1
    s_branch L_p1_ok
L_ag0_slow:
    s_mov_b32 s47, 0
L_ag0_lp:
    s_add_u32 s66, s101, 0
    buffer_load_dwordx4 v[128:131], v2, s[8:11], s66 offen offset:0 sc1
    buffer_load_dwordx4 v[132:135], v2, s[8:11], s66 offen offset:1024 sc1
    buffer_load_dwordx4 v[136:139], v2, s[8:11], s66 offen offset:2048 sc1
    buffer_load_dwordx4 v[140:143], v2, s[8:11], s66 offen offset:3072 sc1
    s_add_u32 s66, s101, 4096
    buffer_load_dwordx4 v[144:147], v2, s[8:11], s66 offen offset:0 sc1
    buffer_load_dwordx4 v[148:151], v2, s[8:11], s66 offen offset:1024 sc1
    buffer_load_dwordx4 v[152:155], v2, s[8:11], s66 offen offset:2048 sc1
    buffer_load_dwordx4 v[156:159], v2, s[8:11], s66 offen offset:3072 sc1
    s_add_u32 s47, s47, 1
    s_waitcnt vmcnt(0)
    v_max3_u32 v31, v128, v132, v136
    v_max3_u32 v31, v31, v140, v144
    v_max3_u32 v31, v31, v148, v152
    v_max3_u32 v31, v31, v156, v156
    v_cmp_eq_u32 vcc, -1, v31
    s_cmp_gt_u32 s47, 60000
    s_cbranch_scc1 L_ag0_ok
    s_cbranch_vccnz L_ag0_lp
    s_branch L_ag0_ok
L_ts1:
    s_branch L_ts5
L_ag1_slow:
    s_mov_b32 s47, 0
L_ag1_lp:
    s_add_u32 s66, s101, 4096
    buffer_load_dwordx4 v[144:147], v2, s[8:11], s66 offen offset:0 sc1
    buffer_load_dwordx4 v[148:151], v2, s[8:11], s66 offen offset:1024 sc1
    buffer_load_dwordx4 v[152:155], v2, s[8:11], s66 offen offset:2048 sc1
    buffer_load_dwordx4 v[156:159], v2, s[8:11], s66 offen offset:3072 sc1
    s_add_u32 s47, s47, 1
    s_waitcnt vmcnt(0)
    v_max3_u32 v31, v144, v148, v152
    v_max3_u32 v31, v31, v156, v156
    v_cmp_eq_u32 vcc, -1, v31
    s_cmp_gt_u32 s47, 60000
    s_cbranch_scc1 L_ag1_ok
    s_cbranch_vccnz L_ag1_lp
    s_branch L_ag1_ok
L_ag2_slow:
    s_mov_b32 s47, 0
L_ag2_lp:
    s_add_u32 s66, s101, 8192
    buffer_load_dwordx4 v[160:163], v2, s[8:11], s66 offen offset:0 sc1
    buffer_load_dwordx4 v[164:167], v2, s[8:11], s66 offen offset:1024 sc1
    buffer_load_dwordx4 v[168:171], v2, s[8:11], s66 offen offset:2048 sc1
    buffer_load_dwordx4 v[172:175], v2, s[8:11], s66 offen offset:3072 sc1
    s_add_u32 s47, s47, 1
    s_waitcnt vmcnt(0)
    v_max3_u32 v31, v160, v164, v168
    v_max3_u32 v31, v31, v172, v172
    v_cmp_eq_u32 vcc, -1, v31
    s_cmp_gt_u32 s47, 60000
    s_cbranch_scc1 L_ag2_ok
    s_cbranch_vccnz L_ag2_lp
    s_branch L_ag2_ok
L_ts2:
    s_branch L_ts6
L_ag3_slow:
    s_mov_b32 s47, 0
L_ag3_lp:
    s_add_u32 s66, s101, 12288
    buffer_load_dwordx4 v[176:179], v2, s[8:11], s66 offen offset:0 sc1
    buffer_load_dwordx4 v[180:183], v2, s[8:11], s66 offen offset:1024 sc1
    buffer_load_dwordx4 v[184:187], v2, s[8:11], s66 offen offset:2048 sc1
    buffer_load_dwordx4 v[188:191], v2, s[8:11], s66 offen offset:3072 sc1
    s_add_u32 s47, s47, 1
    s_waitcnt vmcnt(0)
    v_max3_u32 v31, v176, v180, v184
    v_max3_u32 v31, v31, v188, v188
    v_cmp_eq_u32 vcc, -1, v31
    s_cmp_gt_u32 s47, 60000
    s_cbranch_scc1 L_ag3_ok
    s_cbranch_vccnz L_ag3_lp
    s_branch L_ag3_ok
L_ag4_slow:
    s_mov_b32 s47, 0
L_ag4_lp:
    s_add_u32 s66, s101, 16384
    buffer_load_dwordx4 v[192:195], v2, s[8:11], s66 offen offset:0 sc1
    buffer_load_dwordx4 v[196:199], v2, s[8:11], s66 offen offset:1024 sc1
    buffer_load_dwordx4 v[200:203], v2, s[8:11], s66 offen offset:2048 sc1
    buffer_load_dwordx4 v[204:207], v2, s[8:11], s66 offen offset:3072 sc1
    s_add_u32 s47, s47, 1
    s_waitcnt vmcnt(0)
    v_max3_u32 v31, v192, v196, v200
    v_max3_u32 v31, v31, v204, v204
    v_cmp_eq_u32 vcc, -1, v31
    s_cmp_gt_u32 s47, 60000
    s_cbranch_scc1 L_ag4_ok
    s_cbranch_vccnz L_ag4_lp
    s_branch L_ag4_ok
L_ag5_slow:
    s_mov_b32 s47, 0
L_ag5_lp:
    s_add_u32 s66, s101, 20480
    buffer_load_dwordx4 v[208:211], v2, s[8:11], s66 offen offset:0 sc1
    buffer_load_dwordx4 v[212:215], v2, s[8:11], s66 offen offset:1024 sc1
    buffer_load_dwordx4 v[216:219], v2, s[8:11], s66 offen offset:2048 sc1
    buffer_load_dwordx4 v[220:223], v2, s[8:11], s66 offen offset:3072 sc1
    s_add_u32 s47, s47, 1
    s_waitcnt vmcnt(0)
    v_max3_u32 v31, v208, v212, v216
    v_max3_u32 v31, v31, v220, v220
    v_cmp_eq_u32 vcc, -1, v31
    s_cmp_gt_u32 s47, 60000
    s_cbranch_scc1 L_ag5_ok
    s_cbranch_vccnz L_ag5_lp
    s_branch L_ag5_ok
L_ts3:
    s_branch L_ts7
L_ag6_slow:
    s_mov_b32 s47, 0
L_ag6_lp:
    s_add_u32 s66, s101, 24576
    buffer_load_dwordx4 v[224:227], v2, s[8:11], s66 offen offset:0 sc1
    buffer_load_dwordx4 v[228:231], v2, s[8:11], s66 offen offset:1024 sc1
    buffer_load_dwordx4 v[232:235], v2, s[8:11], s66 offen offset:2048 sc1
    buffer_load_dwordx4 v[236:239], v2, s[8:11], s66 offen offset:3072 sc1
    s_add_u32 s47, s47, 1
    s_waitcnt vmcnt(0)
    v_max3_u32 v31, v224, v228, v232
    v_max3_u32 v31, v31, v236, v236
    v_cmp_eq_u32 vcc, -1, v31
    s_cmp_gt_u32 s47, 60000
    s_cbranch_scc1 L_ag6_ok
    s_cbranch_vccnz L_ag6_lp
    s_branch L_ag6_ok
L_ss_slow:
    s_mov_b32 s47, 0
L_ss_lp:
    buffer_load_dword v120, v16, s[8:11], s46 offen offset:0 sc1
    buffer_load_dword v121, v16, s[8:11], s46 offen offset:128 sc1
    buffer_load_dword v122, v16, s[8:11], s46 offen offset:256 sc1
    buffer_load_dword v123, v16, s[8:11], s46 offen offset:384 sc1
    buffer_load_dword v124, v16, s[8:11], s46 offen offset:512 sc1
    buffer_load_dword v125, v16, s[8:11], s46 offen offset:640 sc1
    buffer_load_dword v126, v16, s[8:11], s46 offen offset:768 sc1
    buffer_load_dword v127, v16, s[8:11], s46 offen offset:896 sc1
    s_add_u32 s47, s47, 1
    s_waitcnt vmcnt(0)
    v_max3_u32 v31, v120, v121, v122
    v_max3_u32 v31, v31, v123, v124
    v_max3_u32 v31, v31, v125, v126
    v_max3_u32 v31, v31, v127, v127
    v_cmp_eq_u32 vcc, -1, v31
    s_cmp_gt_u32 s47, 60000
    s_cbranch_scc1 L_ss_ok
    s_cbranch_vccnz L_ss_lp
    s_branch L_ss_ok
L_ts4:
    s_branch L_ts_ret
L_ag7_slow:
    s_mov_b32 s47, 0
L_ag7_lp:
    s_add_u32 s66, s101, 28672
    buffer_load_dwordx4 v[240:243], v2, s[8:11], s66 offen offset:0 sc1
    buffer_load_dwordx4 v[244:247], v2, s[8:11], s66 offen offset:1024 sc1
    buffer_load_dwordx4 v[248:251], v2, s[8:11], s66 offen offset:2048 sc1
    buffer_load_dwordx4 v[252:255], v2, s[8:11], s66 offen offset:3072 sc1
    s_add_u32 s47, s47, 1
    s_waitcnt vmcnt(0)
    v_max3_u32 v31, v240, v244, v248
    v_max3_u32 v31, v31, v252, v252
    v_cmp_eq_u32 vcc, -1, v31
    s_cmp_gt_u32 s47, 60000
    s_cbranch_scc1 L_ag7_ok
    s_cbranch_vccnz L_ag7_lp
    s_branch L_ag7_ok
L_f30_slow:
    s_mov_b32 s47, 0
L_f30_lp:
    s_mov_b64 exec, vcc
    buffer_load_dword v28, v19, s[8:11], s58 offen offset:16 sc1
    s_add_u32 s47, s47, 1
    s_waitcnt vmcnt(0)
    v_cmp_ne_u32 vcc, v30, v28
    s_cmp_gt_u32 s47, 60000
    s_cbranch_scc1 L_f30_x
    s_cbranch_vccnz L_f30_lp
L_f30_x:
    s_mov_b64 exec, -1
    s_branch L_f30_ok
L_ts5:
    s_branch L_ts_ret
L_g2_slow:
    s_mov_b32 s47, 0
L_g2_lp:
    buffer_load_dwordx4 v[128:131], v2, s[8:11], s49 offen offset:2048 sc1
    buffer_load_dwordx4 v[132:135], v2, s[8:11], s50 offen offset:2048 sc1
    buffer_load_dwordx4 v[136:139], v2, s[8:11], s51 offen offset:2048 sc1
    s_add_u32 s47, s47, 1
    s_waitcnt vmcnt(0)
    v_max3_u32 v31, v128, v132, v136
    v_cmp_eq_u32 vcc, -1, v31
    s_cmp_gt_u32 s47, 60000
    s_cbranch_scc1 L_g2_ok
    s_cbranch_vccnz L_g2_lp
    s_branch L_g2_ok
L_g3_slow:
    s_mov_b32 s47, 0
L_g3_lp:
    buffer_load_dwordx4 v[140:143], v2, s[8:11], s49 offen offset:3072 sc1
    buffer_load_dwordx4 v[144:147], v2, s[8:11], s50 offen offset:3072 sc1
    buffer_load_dwordx4 v[148:151], v2, s[8:11], s51 offen offset:3072 sc1
    s_add_u32 s47, s47, 1
    s_waitcnt vmcnt(0)
    v_max3_u32 v31, v140, v144, v148
    v_cmp_eq_u32 vcc, -1, v31
    s_cmp_gt_u32 s47, 60000
    s_cbranch_scc1 L_g3_ok
    s_cbranch_vccnz L_g3_lp
    s_branch L_g3_ok
L_gX_slow:
    s_mov_b32 s47, 0
L_gX_lp:
    buffer_load_dwordx4 v[152:155], v2, s[8:11], s53 offen offset:0 sc1
    buffer_load_dwordx4 v[156:159], v2, s[8:11], s54 offen offset:0 sc1
    buffer_load_dwordx4 v[160:163], v2, s[8:11], s55 offen offset:0 sc1
    s_add_u32 s47, s47, 1
    s_waitcnt vmcnt(0)
    v_max3_u32 v31, v152, v156, v160
    v_cmp_eq_u32 vcc, -1, v31
    s_cmp_gt_u32 s47, 60000
    s_cbranch_scc1 L_gX_ok
    s_cbranch_vccnz L_gX_lp
    s_branch L_gX_ok
L_ts6:
    s_branch L_ts_ret
L_gY_slow:
    s_mov_b32 s47, 0
L_gY_lp:
    buffer_load_dwordx4 v[164:167], v2, s[8:11], s53 offen offset:1024 sc1
    buffer_load_dwordx4 v[168:171], v2, s[8:11], s54 offen offset:1024 sc1
    buffer_load_dwordx4 v[172:175], v2, s[8:11], s55 offen offset:1024 sc1
    s_add_u32 s47, s47, 1
    s_waitcnt vmcnt(0)
    v_max3_u32 v31, v164, v168, v172
    v_cmp_eq_u32 vcc, -1, v31
    s_cmp_gt_u32 s47, 60000
    s_cbranch_scc1 L_gY_ok
    s_cbranch_vccnz L_gY_lp
    s_branch L_gY_ok
L_gZ_slow:
    s_mov_b32 s47, 0
L_gZ_lp:
    buffer_load_dwordx4 v[176:179], v2, s[8:11], s53 offen offset:2048 sc1
    buffer_load_dwordx4 v[180:183], v2, s[8:11], s54 offen offset:2048 sc1
    buffer_load_dwordx4 v[184:187], v2, s[8:11], s55 offen offset:2048 sc1
    buffer_load_dwordx4 v[188:191], v2, s[8:11], s92 offen offset:2048 sc1
    buffer_load_dwordx4 v[192:195], v2, s[8:11], s93 offen offset:2048 sc1
    buffer_load_dwordx4 v[196:199], v2, s[8:11], s94 offen offset:2048 sc1
    buffer_load_dwordx4 v[200:203], v2, s[8:11], s95 offen offset:2048 sc1
    s_add_u32 s47, s47, 1
    s_waitcnt vmcnt(0)
    v_max3_u32 v31, v176, v180, v184
    v_max3_u32 v31, v31, v188, v192
    v_max3_u32 v31, v31, v196, v200
    v_cmp_eq_u32 vcc, -1, v31
    s_cmp_gt_u32 s47, 60000
    s_cbranch_scc1 L_gZ_ok
    s_cbranch_vccnz L_gZ_lp
    s_branch L_gZ_ok
L_ts7:
    s_branch L_ts_ret
L_pp2_slow:
    s_mov_b32 s47, 0
L_pp2_lp:
    buffer_load_dwordx4 v[204:207], v2, s[8:11], s65 offen offset:2048 sc1
    buffer_load_dwordx4 v[208:211], v2, s[8:11], s65 offen offset:3072 sc1
    s_add_u32 s47, s47, 1
    s_waitcnt vmcnt(0)
    v_xor_b32 v204, v21, v204
    v_xor_b32 v205, v21, v205
    v_xor_b32 v206, v21, v206
    v_xor_b32 v207, v21, v207
    v_xor_b32 v208, v21, v208
    v_xor_b32 v209, v21, v209
    v_xor_b32 v210, v21, v210
    v_xor_b32 v211, v21, v211
    v_or3_b32 v31, v204, v205, v206
    v_or3_b32 v31, v31, v207, v208
    v_or3_b32 v31, v31, v209, v210
    v_or_b32 v31, v31, v211
    v_and_b32 v31, 0x10001, v31
    v_cmp_ne_u32 vcc, 0, v31
    s_cmp_gt_u32 s47, 60000
    s_cbranch_scc1 L_pp2_ok
    s_cbranch_vccnz L_pp2_lp
    s_branch L_pp2_ok
L_pp3_slow:
    s_mov_b32 s47, 0
L_pp3_lp:
    buffer_load_dwordx4 v[212:215], v2, s[8:11], s3 offen offset:0 sc1
    buffer_load_dwordx4 v[216:219], v2, s[8:11], s3 offen offset:1024 sc1
    s_add_u32 s47, s47, 1
    s_waitcnt vmcnt(0)
    v_xor_b32 v212, v21, v212
    v_xor_b32 v213, v21, v213
    v_xor_b32 v214, v21, v214
    v_xor_b32 v215, v21, v215
    v_xor_b32 v216, v21, v216
    v_xor_b32 v217, v21, v217
    v_xor_b32 v218, v21, v218
    v_xor_b32 v219, v21, v219
    v_or3_b32 v31, v212, v213, v214
    v_or3_b32 v31, v31, v215, v216
    v_or3_b32 v31, v31, v217, v218
    v_or_b32 v31, v31, v219
    v_and_b32 v31, 0x10001, v31
    v_cmp_ne_u32 vcc, 0, v31
    s_cmp_gt_u32 s47, 60000
    s_cbranch_scc1 L_pp3_ok
    s_cbranch_vccnz L_pp3_lp
    s_branch L_pp3_ok
L_pp1_slow:
    s_mov_b32 s47, 0
L_pp1_lp:
    buffer_load_dwordx4 v[36:39], v2, s[8:11], s65 offen offset:0 sc1
    buffer_load_dwordx4 v[40:43], v2, s[8:11], s65 offen offset:1024 sc1
    s_add_u32 s47, s47, 1
    s_waitcnt vmcnt(0)
    v_xor_b32 v36, v21, v36
    v_xor_b32 v37, v21, v37
    v_xor_b32 v38, v21, v38
    v_xor_b32 v39, v21, v39
    v_xor_b32 v40, v21, v40
    v_xor_b32 v41, v21, v41
    v_xor_b32 v42, v21, v42
    v_xor_b32 v43, v21, v43
    v_or3_b32 v31, v36, v37, v38
    v_or3_b32 v31, v31, v39, v40
    v_or3_b32 v31, v31, v41, v42
    v_or_b32 v31, v31, v43
    v_and_b32 v31, 0x10001, v31
    v_cmp_ne_u32 vcc, 0, v31
    s_cmp_gt_u32 s47, 60000
    s_cbranch_scc1 L_pp1_ok
    s_cbranch_vccnz L_pp1_lp
    s_branch L_pp1_ok
L_last:
    s_endpgm
.section .rodata,"a"
.p2align 6
.amdhsa_kernel sequential_preLN__spectral_fnet__swiglu_ffn__prompt_kernel
  .amdhsa_next_free_vgpr 512
  .amdhsa_next_free_sgpr 102
  .amdhsa_accum_offset 256
  .amdhsa_group_segment_fixed_size 0
  .amdhsa_kernarg_size 96
  .amdhsa_user_sgpr_count 2
  .amdhsa_user_sgpr_kernarg_segment_ptr 1
  .amdhsa_system_sgpr_workgroup_id_x 1
.end_amdhsa_kernel
```
